```python
import torch

def _softmax(x, axis=-1):
    return torch.softmax(x, dim=axis)
def _gelu(x):
    return torch.nn.functional.gelu(x, approximate="tanh")
def _silu(x):
    return torch.nn.functional.silu(x)
def _sigmoid(x):
    return torch.sigmoid(x)
def _layernorm(x, axis=-1, eps=1e-5):
    m = x.mean(dim=axis, keepdim=True)
    v = x.var(dim=axis, keepdim=True, unbiased=False)
    return (x - m) / torch.sqrt(v + eps)
def _scatter_add(tgt, idx, src, axis=0):
    return tgt.clone().index_add_(axis, idx, src)
def _segment_sum(src, seg, n):
    out = torch.zeros((n,) + src.shape[1:], dtype=src.dtype)
    return out.index_add_(0, seg, src)
def _pad(x, pw):
    flat = tuple(v for pair in reversed(pw) for v in pair)
    return torch.nn.functional.pad(x, flat)

kernel_name = 'sequential_preLN__gqa_block_cached__geglu_ffn__decode'

def setup_inputs():

    _w = (lambda a: (lambda t: t.to(torch.bfloat16) if t.is_floating_point() else t)(torch.as_tensor(a)))
    def _A_setup():
        B, Sq, D = 2, 1, 448
        Hq, Hkv, Sk, Dh = 16, 8, 32768, 256
        assert Hq % Hkv == 0, (Hq, Hkv)
        return {
            "x": _w((lambda *s: torch.randn(*s, dtype=torch.bfloat16) * 0.05)(B, Sq, D)),
            "k_cache": _w((lambda *s: torch.randn(*s, dtype=torch.bfloat16) * 3.2)(B, Hkv, Sk, Dh)),
            "v_cache": _w((lambda *s: torch.randn(*s, dtype=torch.bfloat16) * 0.4)(B, Hkv, Sk, Dh)),
            "wq": _w((lambda *s: torch.randn(*s, dtype=torch.bfloat16) * 3.2)(D, Hq * Dh) * (D ** -0.5)),
            "wo": _w((lambda *s: torch.randn(*s, dtype=torch.bfloat16) * 0.4)(Hq * Dh, D) * ((Hq * Dh) ** -0.5)),
        }
    _A_in = _A_setup()

    def _B_setup():
        B, S, D, F = 2, 1, 448, 1792
        return {
            "x": _w((lambda *s: torch.randn(*s, dtype=torch.bfloat16) * 0.05)(B, S, D)),
            "w_gate": _w((lambda *s: torch.randn(*s, dtype=torch.bfloat16) * 0.05)(D, F)),
            "w_up": _w((lambda *s: torch.randn(*s, dtype=torch.bfloat16) * 0.05)(D, F)),
            "w_down": _w((lambda *s: torch.randn(*s, dtype=torch.bfloat16) * 0.05)(F, D)),
        }
    _B_in = _B_setup()

    return {
        "A_x": _A_in["x"],
        "A_k_cache": _A_in["k_cache"],
        "A_v_cache": _A_in["v_cache"],
        "A_wq": _A_in["wq"],
        "A_wo": _A_in["wo"],
        "B_x": _B_in["x"],
        "B_w_gate": _B_in["w_gate"],
        "B_w_up": _B_in["w_up"],
        "B_w_down": _B_in["w_down"],
    }

def reference(A_x, A_k_cache, A_v_cache, A_wq, A_wo, B_x, B_w_gate, B_w_up, B_w_down):
    def _A_ref(x, k_cache, v_cache, wq, wo):
        B, Sq, D = x.shape
        Hq, Dh = 16, 256
        Hkv = k_cache.shape[1]
        rep = Hq // Hkv
        q = (lambda x, *d: x.permute(*d))((x @ wq).reshape(B, Sq, Hq, Dh), 0, 2, 1, 3)
        k = (lambda x, n, axis: torch.repeat_interleave(x, n, dim=axis))(k_cache, rep, axis=1)
        v = (lambda x, n, axis: torch.repeat_interleave(x, n, dim=axis))(v_cache, rep, axis=1)
        scores = torch.einsum("bhqd,bhkd->bhqk", q, k) * (Dh ** -0.5)
        p = _softmax(scores, axis=-1)
        o = torch.einsum("bhqk,bhkd->bhqd", p, v)
        return (lambda x, *d: x.permute(*d))(o, 0, 2, 1, 3).reshape(B, Sq, Hq * Dh) @ wo

    def _B_ref(x, w_gate, w_up, w_down):
        return (_gelu(x @ w_gate) * (x @ w_up)) @ w_down

    x = A_x
    h = x + _A_ref(_layernorm(x, axis=-1), A_k_cache, A_v_cache, A_wq, A_wo)
    h2 = h + _B_ref(_layernorm(h, axis=-1), B_w_gate, B_w_up, B_w_down)
    return h2
```

```asm
; @launch grid=(256,1,1) block=(512,1,1) lds=135168
.amdgcn_target "amdgcn-amd-amdhsa--gfx950"
.text
.globl sequential_preLN__gqa_block_cached__geglu_ffn__decode_kernel
.p2align 8
.type sequential_preLN__gqa_block_cached__geglu_ffn__decode_kernel,@function
sequential_preLN__gqa_block_cached__geglu_ffn__decode_kernel:
  s_cmp_ge_u32 s2, 256
  s_cbranch_scc1 L_exit
  s_load_dwordx16 s[16:31], s[0:1], 0
  s_load_dwordx8 s[32:39], s[0:1], 64
  v_lshrrev_b32 v2, 6, v0
  v_and_b32 v1, 63, v0
  v_readfirstlane_b32 s3, v2
  s_nop 0
  s_and_b32 s8, s3, 3
  s_cmp_lt_u32 s3, 4
  s_cbranch_scc1 L_hpath
  v_and_b32 v12, 15, v1
  v_lshrrev_b32 v13, 4, v1
  v_and_b32 v14, 7, v12
  v_lshrrev_b32 v15, 3, v12
  v_lshlrev_b32 v2, 9, v14
  v_lshl_add_u32 v16, v15, 2, v13
  v_lshl_add_u32 v2, v16, 4, v2
  v_add_u32 v3, 0x1000, v2
  v_lshlrev_b32 v4, 11, v13
  v_lshl_add_u32 v4, v12, 4, v4
  s_lshl_b32 s70, s8, 2
  v_mov_b32 v0, s70
  v_mov_b32 v79, 0
  ds_write_b32 v0, v79 offset:176
  s_mov_b32 s68, 0
  s_lshl_b32 s64, s2, 20
  s_lshl_b32 s65, s8, 13
  s_add_u32 s64, s64, s65
  s_and_b32 s69, s2, 31
  s_lshl_b32 s69, s69, 15
  s_waitcnt lgkmcnt(0)
  s_mov_b32 s40, s18
  s_mov_b32 s41, s19
  s_mov_b32 s42, 268435456
  s_mov_b32 s43, 0x20000
  s_mov_b32 s44, s20
  s_mov_b32 s45, s21
  s_mov_b32 s46, 268435456
  s_mov_b32 s47, 0x20000
  s_add_u32 s65, s69, 0
  s_and_b32 s65, s65, 0xfffff
  s_add_u32 s65, s65, s64
  buffer_load_dwordx4 v[80:83], v2, s[40:43], s65 offen offset:0 nt
  buffer_load_dwordx4 v[84:87], v2, s[40:43], s65 offen offset:128 nt
  buffer_load_dwordx4 v[88:91], v2, s[40:43], s65 offen offset:256 nt
  buffer_load_dwordx4 v[92:95], v2, s[40:43], s65 offen offset:384 nt
  buffer_load_dwordx4 v[96:99], v3, s[40:43], s65 offen offset:0 nt
  buffer_load_dwordx4 v[100:103], v3, s[40:43], s65 offen offset:128 nt
  s_waitcnt vmcnt(5)
  buffer_load_dwordx4 v[104:107], v3, s[40:43], s65 offen offset:256 nt
  s_waitcnt vmcnt(5)
  buffer_load_dwordx4 v[108:111], v3, s[40:43], s65 offen offset:384 nt
  s_mov_b32 s48, s38
  s_mov_b32 s49, s39
  s_mov_b32 s50, 4194304
  s_mov_b32 s51, 0x20000
  s_mov_b32 s10, 0x3db8aa3b
  v_lshrrev_b32 v16, 1, v14
  v_and_b32 v17, 1, v14
  v_mov_b32 v18, 0xffff
  v_lshlrev_b32 v17, 4, v17
  v_lshlrev_b32 v18, v17, v18
  v_cmp_eq_u32 vcc, 0, v16
  s_nop 1
  v_cndmask_b32 v5, 0, v18, vcc
  v_cmp_eq_u32 vcc, 1, v16
  s_nop 1
  v_cndmask_b32 v6, 0, v18, vcc
  v_cmp_eq_u32 vcc, 2, v16
  s_nop 1
  v_cndmask_b32 v7, 0, v18, vcc
  v_cmp_eq_u32 vcc, 3, v16
  s_nop 1
  v_cndmask_b32 v8, 0, v18, vcc
  v_mov_b32 v9, 0xff800000
  v_mov_b32 v11, 0x7f800000
  v_mov_b32 v10, 0
  v_mov_b32 v36, 0
  v_mov_b32 v37, 0
  v_mov_b32 v38, 0
  v_mov_b32 v39, 0
  v_mov_b32 v40, 0
  v_mov_b32 v41, 0
  v_mov_b32 v42, 0
  v_mov_b32 v43, 0
  v_bfe_u32 v16, v12, 2, 1
  v_lshl_add_u32 v16, v16, 2, v13
  v_lshlrev_b32 v23, 9, v15
  v_lshl_add_u32 v23, v16, 4, v23
  v_lshrrev_b32 v16, 1, v13
  v_and_b32 v17, 1, v13
  v_lshlrev_b32 v76, 10, v16
  v_lshl_add_u32 v76, v12, 5, v76
  v_lshl_add_u32 v76, v17, 4, v76
  s_lshl_b32 s70, s8, 11
  v_add_u32 v76, s70, v76
  s_lshl_b32 s70, s8, 4
  v_add_u32 v77, s70, v1
  v_mov_b32 v78, 1
  v_mov_b32 v79, 0
  v_lshl_add_u32 v20, v15, 2, v13
  v_lshlrev_b32 v20, 3, v20
  s_lshl_b32 s70, s8, 11
  v_add_u32 v20, s70, v20
  v_mov_b32 v21, v20
  s_lshl_b32 s70, s8, 2
  v_mov_b32 v0, s70
  s_add_u32 s65, s69, 32768
  s_and_b32 s65, s65, 0xfffff
  s_add_u32 s65, s65, s64
  s_waitcnt vmcnt(5)
  buffer_load_dwordx4 v[112:115], v2, s[40:43], s65 offen offset:0 nt
  s_waitcnt vmcnt(5)
  buffer_load_dwordx4 v[116:119], v2, s[40:43], s65 offen offset:128 nt
  s_waitcnt vmcnt(5)
  buffer_load_dwordx4 v[120:123], v2, s[40:43], s65 offen offset:256 nt
  s_waitcnt vmcnt(5)
  buffer_load_dwordx4 v[124:127], v2, s[40:43], s65 offen offset:384 nt
  s_waitcnt vmcnt(5)
  buffer_load_dwordx4 v[128:131], v3, s[40:43], s65 offen offset:0 nt
  s_waitcnt vmcnt(5)
  buffer_load_dwordx4 v[132:135], v3, s[40:43], s65 offen offset:128 nt
  s_waitcnt vmcnt(5)
  buffer_load_dwordx4 v[136:139], v3, s[40:43], s65 offen offset:256 nt
  s_waitcnt vmcnt(5)
  buffer_load_dwordx4 v[140:143], v3, s[40:43], s65 offen offset:384 nt
  s_add_u32 s65, s69, 65536
  s_and_b32 s65, s65, 0xfffff
  s_add_u32 s65, s65, s64
  s_waitcnt vmcnt(5)
  buffer_load_dwordx4 v[144:147], v2, s[40:43], s65 offen offset:0 nt
  s_waitcnt vmcnt(5)
  buffer_load_dwordx4 v[148:151], v2, s[40:43], s65 offen offset:128 nt
  s_waitcnt vmcnt(5)
  buffer_load_dwordx4 v[152:155], v2, s[40:43], s65 offen offset:256 nt
  s_waitcnt vmcnt(5)
  buffer_load_dwordx4 v[156:159], v2, s[40:43], s65 offen offset:384 nt
  s_waitcnt vmcnt(5)
  buffer_load_dwordx4 v[160:163], v3, s[40:43], s65 offen offset:0 nt
  s_waitcnt vmcnt(5)
  buffer_load_dwordx4 v[164:167], v3, s[40:43], s65 offen offset:128 nt
  s_waitcnt vmcnt(5)
  buffer_load_dwordx4 v[168:171], v3, s[40:43], s65 offen offset:256 nt
  s_waitcnt vmcnt(5)
  buffer_load_dwordx4 v[172:175], v3, s[40:43], s65 offen offset:384 nt
  s_add_u32 s65, s69, 98304
  s_and_b32 s65, s65, 0xfffff
  s_add_u32 s65, s65, s64
  s_waitcnt vmcnt(5)
  buffer_load_dwordx4 v[176:179], v2, s[40:43], s65 offen offset:0 nt
  ds_write_b32 v0, v78 offset:176
  s_waitcnt vmcnt(5)
  buffer_load_dwordx4 v[180:183], v2, s[40:43], s65 offen offset:128 nt
  s_waitcnt vmcnt(5)
  buffer_load_dwordx4 v[184:187], v2, s[40:43], s65 offen offset:256 nt
  s_waitcnt vmcnt(5)
  buffer_load_dwordx4 v[188:191], v2, s[40:43], s65 offen offset:384 nt
  s_waitcnt vmcnt(5)
  buffer_load_dwordx4 v[192:195], v3, s[40:43], s65 offen offset:0 nt
  s_waitcnt vmcnt(5)
  buffer_load_dwordx4 v[196:199], v3, s[40:43], s65 offen offset:128 nt
  s_waitcnt vmcnt(5)
  buffer_load_dwordx4 v[200:203], v3, s[40:43], s65 offen offset:256 nt
  s_waitcnt vmcnt(5)
  buffer_load_dwordx4 v[204:207], v3, s[40:43], s65 offen offset:384 nt
  s_add_u32 s65, s69, 131072
  s_and_b32 s65, s65, 0xfffff
  s_add_u32 s65, s65, s64
  s_waitcnt vmcnt(5)
  buffer_load_dwordx4 v[208:211], v2, s[40:43], s65 offen offset:0 nt
  s_waitcnt vmcnt(5)
  buffer_load_dwordx4 v[212:215], v2, s[40:43], s65 offen offset:128 nt
  s_waitcnt vmcnt(5)
  buffer_load_dwordx4 v[216:219], v2, s[40:43], s65 offen offset:256 nt
  s_waitcnt vmcnt(5)
  buffer_load_dwordx4 v[220:223], v2, s[40:43], s65 offen offset:384 nt
  s_waitcnt vmcnt(5)
  buffer_load_dwordx4 v[224:227], v3, s[40:43], s65 offen offset:0 nt
  s_waitcnt vmcnt(5)
  buffer_load_dwordx4 v[228:231], v3, s[40:43], s65 offen offset:128 nt
  s_waitcnt vmcnt(5)
  buffer_load_dwordx4 v[232:235], v3, s[40:43], s65 offen offset:256 nt
  s_waitcnt vmcnt(5)
  buffer_load_dwordx4 v[236:239], v3, s[40:43], s65 offen offset:384 nt
  s_barrier
  ds_read_b128 v[60:63], v23 offset:256
  ds_read_b128 v[64:67], v23 offset:384
  ds_read_b128 v[68:71], v23 offset:512
  ds_read_b128 v[72:75], v23 offset:640
  ds_read_b32 v23, v79 offset:128
  s_waitcnt lgkmcnt(0)
  v_readfirstlane_b32 s9, v23
  s_waitcnt vmcnt(39)
  v_mfma_f32_16x16x32_bf16 v[28:31], v[80:83], v[60:63], 0
  s_waitcnt vmcnt(38)
  v_mfma_f32_16x16x32_bf16 v[28:31], v[84:87], v[64:67], v[28:31]
  s_waitcnt vmcnt(37)
  v_mfma_f32_16x16x32_bf16 v[28:31], v[88:91], v[68:71], v[28:31]
  s_waitcnt vmcnt(36)
  v_mfma_f32_16x16x32_bf16 v[28:31], v[92:95], v[72:75], v[28:31]
  s_waitcnt vmcnt(35)
  v_mfma_f32_16x16x32_bf16 v[32:35], v[96:99], v[60:63], 0
  s_waitcnt vmcnt(34)
  v_mfma_f32_16x16x32_bf16 v[32:35], v[100:103], v[64:67], v[32:35]
  s_waitcnt vmcnt(33)
  v_mfma_f32_16x16x32_bf16 v[32:35], v[104:107], v[68:71], v[32:35]
  s_waitcnt vmcnt(32)
  v_mfma_f32_16x16x32_bf16 v[32:35], v[108:111], v[72:75], v[32:35]
  s_nop 7
  v_permlane32_swap_b32 v28, v32
  v_permlane32_swap_b32 v29, v33
  v_permlane32_swap_b32 v30, v34
  v_permlane32_swap_b32 v31, v35
  v_add_f32_dpp v12, v32, v28 row_half_mirror row_mask:0xf bank_mask:0x5
  v_add_f32_dpp v13, v33, v29 row_half_mirror row_mask:0xf bank_mask:0x5
  v_add_f32_dpp v14, v34, v30 row_half_mirror row_mask:0xf bank_mask:0x5
  v_add_f32_dpp v15, v35, v31 row_half_mirror row_mask:0xf bank_mask:0x5
  v_add_f32_dpp v12, v28, v32 row_half_mirror row_mask:0xf bank_mask:0xa
  v_add_f32_dpp v13, v29, v33 row_half_mirror row_mask:0xf bank_mask:0xa
  v_add_f32_dpp v14, v30, v34 row_half_mirror row_mask:0xf bank_mask:0xa
  v_add_f32_dpp v15, v31, v35 row_half_mirror row_mask:0xf bank_mask:0xa
  v_cvt_pk_bf16_f32 v16, v12, v13
  v_cvt_pk_bf16_f32 v17, v14, v15
  v_max3_f32 v9, v12, v13, v9
  ds_write_b64 v20, v[16:17] offset:12288
  v_max3_f32 v9, v14, v15, v9
  s_waitcnt vmcnt(31)
  v_mfma_f32_16x16x32_bf16 v[28:31], v[112:115], v[60:63], 0
  s_waitcnt vmcnt(30)
  v_mfma_f32_16x16x32_bf16 v[28:31], v[116:119], v[64:67], v[28:31]
  s_add_u32 s66, s69, 163840
  s_and_b32 s66, s66, 0xfffff
  s_add_u32 s66, s66, s64
  s_waitcnt vmcnt(5)
  buffer_load_dwordx4 v[112:115], v2, s[40:43], s66 offen offset:0 nt
  s_waitcnt vmcnt(30)
  v_mfma_f32_16x16x32_bf16 v[28:31], v[120:123], v[68:71], v[28:31]
  s_waitcnt vmcnt(29)
  v_mfma_f32_16x16x32_bf16 v[28:31], v[124:127], v[72:75], v[28:31]
  s_waitcnt vmcnt(5)
  buffer_load_dwordx4 v[116:119], v2, s[40:43], s66 offen offset:128 nt
  s_waitcnt vmcnt(29)
  v_mfma_f32_16x16x32_bf16 v[32:35], v[128:131], v[60:63], 0
  s_waitcnt vmcnt(28)
  v_mfma_f32_16x16x32_bf16 v[32:35], v[132:135], v[64:67], v[32:35]
  s_waitcnt vmcnt(5)
  buffer_load_dwordx4 v[120:123], v2, s[40:43], s66 offen offset:256 nt
  s_waitcnt vmcnt(28)
  v_mfma_f32_16x16x32_bf16 v[32:35], v[136:139], v[68:71], v[32:35]
  s_waitcnt vmcnt(27)
  v_mfma_f32_16x16x32_bf16 v[32:35], v[140:143], v[72:75], v[32:35]
  s_waitcnt vmcnt(5)
  buffer_load_dwordx4 v[124:127], v2, s[40:43], s66 offen offset:384 nt
  s_nop 5
  v_permlane32_swap_b32 v28, v32
  v_permlane32_swap_b32 v29, v33
  v_permlane32_swap_b32 v30, v34
  v_permlane32_swap_b32 v31, v35
  v_add_f32_dpp v12, v32, v28 row_half_mirror row_mask:0xf bank_mask:0x5
  v_add_f32_dpp v13, v33, v29 row_half_mirror row_mask:0xf bank_mask:0x5
  v_add_f32_dpp v14, v34, v30 row_half_mirror row_mask:0xf bank_mask:0x5
  v_add_f32_dpp v15, v35, v31 row_half_mirror row_mask:0xf bank_mask:0x5
  v_add_f32_dpp v12, v28, v32 row_half_mirror row_mask:0xf bank_mask:0xa
  v_add_f32_dpp v13, v29, v33 row_half_mirror row_mask:0xf bank_mask:0xa
  v_add_f32_dpp v14, v30, v34 row_half_mirror row_mask:0xf bank_mask:0xa
  v_add_f32_dpp v15, v31, v35 row_half_mirror row_mask:0xf bank_mask:0xa
  v_cvt_pk_bf16_f32 v16, v12, v13
  v_cvt_pk_bf16_f32 v17, v14, v15
  v_max3_f32 v9, v12, v13, v9
  ds_write_b64 v20, v[16:17] offset:12352
  v_max3_f32 v9, v14, v15, v9
  s_waitcnt vmcnt(27)
  v_mfma_f32_16x16x32_bf16 v[28:31], v[144:147], v[60:63], 0
  s_waitcnt vmcnt(26)
  v_mfma_f32_16x16x32_bf16 v[28:31], v[148:151], v[64:67], v[28:31]
  s_waitcnt vmcnt(5)
  buffer_load_dwordx4 v[128:131], v3, s[40:43], s66 offen offset:0 nt
  s_waitcnt vmcnt(26)
  v_mfma_f32_16x16x32_bf16 v[28:31], v[152:155], v[68:71], v[28:31]
  s_waitcnt vmcnt(25)
  v_mfma_f32_16x16x32_bf16 v[28:31], v[156:159], v[72:75], v[28:31]
  s_waitcnt vmcnt(5)
  buffer_load_dwordx4 v[132:135], v3, s[40:43], s66 offen offset:128 nt
  s_waitcnt vmcnt(25)
  v_mfma_f32_16x16x32_bf16 v[32:35], v[160:163], v[60:63], 0
  s_waitcnt vmcnt(24)
  v_mfma_f32_16x16x32_bf16 v[32:35], v[164:167], v[64:67], v[32:35]
  s_waitcnt vmcnt(5)
  buffer_load_dwordx4 v[136:139], v3, s[40:43], s66 offen offset:256 nt
  s_waitcnt vmcnt(24)
  v_mfma_f32_16x16x32_bf16 v[32:35], v[168:171], v[68:71], v[32:35]
  s_waitcnt vmcnt(23)
  v_mfma_f32_16x16x32_bf16 v[32:35], v[172:175], v[72:75], v[32:35]
  s_waitcnt vmcnt(5)
  buffer_load_dwordx4 v[140:143], v3, s[40:43], s66 offen offset:384 nt
  s_nop 5
  v_permlane32_swap_b32 v28, v32
  v_permlane32_swap_b32 v29, v33
  v_permlane32_swap_b32 v30, v34
  v_permlane32_swap_b32 v31, v35
  v_add_f32_dpp v12, v32, v28 row_half_mirror row_mask:0xf bank_mask:0x5
  v_add_f32_dpp v13, v33, v29 row_half_mirror row_mask:0xf bank_mask:0x5
  v_add_f32_dpp v14, v34, v30 row_half_mirror row_mask:0xf bank_mask:0x5
  v_add_f32_dpp v15, v35, v31 row_half_mirror row_mask:0xf bank_mask:0x5
  v_add_f32_dpp v12, v28, v32 row_half_mirror row_mask:0xf bank_mask:0xa
  v_add_f32_dpp v13, v29, v33 row_half_mirror row_mask:0xf bank_mask:0xa
  v_add_f32_dpp v14, v30, v34 row_half_mirror row_mask:0xf bank_mask:0xa
  v_add_f32_dpp v15, v31, v35 row_half_mirror row_mask:0xf bank_mask:0xa
  v_cvt_pk_bf16_f32 v16, v12, v13
  v_cvt_pk_bf16_f32 v17, v14, v15
  v_max3_f32 v9, v12, v13, v9
  ds_write_b64 v20, v[16:17] offset:12416
  v_max3_f32 v9, v14, v15, v9
  s_waitcnt vmcnt(23)
  v_mfma_f32_16x16x32_bf16 v[28:31], v[176:179], v[60:63], 0
  s_waitcnt vmcnt(22)
  v_mfma_f32_16x16x32_bf16 v[28:31], v[180:183], v[64:67], v[28:31]
  s_add_u32 s66, s69, 196608
  s_and_b32 s66, s66, 0xfffff
  s_add_u32 s66, s66, s64
  s_waitcnt vmcnt(5)
  buffer_load_dwordx4 v[80:83], v2, s[40:43], s66 offen offset:0 nt
  s_waitcnt vmcnt(22)
  v_mfma_f32_16x16x32_bf16 v[28:31], v[184:187], v[68:71], v[28:31]
  s_waitcnt vmcnt(21)
  v_mfma_f32_16x16x32_bf16 v[28:31], v[188:191], v[72:75], v[28:31]
  s_waitcnt vmcnt(5)
  buffer_load_dwordx4 v[84:87], v2, s[40:43], s66 offen offset:128 nt
  s_waitcnt vmcnt(21)
  v_mfma_f32_16x16x32_bf16 v[32:35], v[192:195], v[60:63], 0
  s_waitcnt vmcnt(20)
  v_mfma_f32_16x16x32_bf16 v[32:35], v[196:199], v[64:67], v[32:35]
  s_waitcnt vmcnt(5)
  buffer_load_dwordx4 v[88:91], v2, s[40:43], s66 offen offset:256 nt
  s_waitcnt vmcnt(20)
  v_mfma_f32_16x16x32_bf16 v[32:35], v[200:203], v[68:71], v[32:35]
  s_waitcnt vmcnt(19)
  v_mfma_f32_16x16x32_bf16 v[32:35], v[204:207], v[72:75], v[32:35]
  s_waitcnt vmcnt(5)
  buffer_load_dwordx4 v[92:95], v2, s[40:43], s66 offen offset:384 nt
  s_nop 5
  v_permlane32_swap_b32 v28, v32
  v_permlane32_swap_b32 v29, v33
  v_permlane32_swap_b32 v30, v34
  v_permlane32_swap_b32 v31, v35
  v_add_f32_dpp v12, v32, v28 row_half_mirror row_mask:0xf bank_mask:0x5
  v_add_f32_dpp v13, v33, v29 row_half_mirror row_mask:0xf bank_mask:0x5
  v_add_f32_dpp v14, v34, v30 row_half_mirror row_mask:0xf bank_mask:0x5
  v_add_f32_dpp v15, v35, v31 row_half_mirror row_mask:0xf bank_mask:0x5
  v_add_f32_dpp v12, v28, v32 row_half_mirror row_mask:0xf bank_mask:0xa
  v_add_f32_dpp v13, v29, v33 row_half_mirror row_mask:0xf bank_mask:0xa
  v_add_f32_dpp v14, v30, v34 row_half_mirror row_mask:0xf bank_mask:0xa
  v_add_f32_dpp v15, v31, v35 row_half_mirror row_mask:0xf bank_mask:0xa
  v_cvt_pk_bf16_f32 v16, v12, v13
  v_cvt_pk_bf16_f32 v17, v14, v15
  v_max3_f32 v9, v12, v13, v9
  ds_write_b64 v20, v[16:17] offset:12480
  v_max3_f32 v9, v14, v15, v9
  s_waitcnt vmcnt(19)
  v_mfma_f32_16x16x32_bf16 v[28:31], v[208:211], v[60:63], 0
  s_waitcnt vmcnt(18)
  v_mfma_f32_16x16x32_bf16 v[28:31], v[212:215], v[64:67], v[28:31]
  s_waitcnt vmcnt(5)
  buffer_load_dwordx4 v[96:99], v3, s[40:43], s66 offen offset:0 nt
  s_waitcnt vmcnt(18)
  v_mfma_f32_16x16x32_bf16 v[28:31], v[216:219], v[68:71], v[28:31]
  s_waitcnt vmcnt(17)
  v_mfma_f32_16x16x32_bf16 v[28:31], v[220:223], v[72:75], v[28:31]
  s_waitcnt vmcnt(5)
  buffer_load_dwordx4 v[100:103], v3, s[40:43], s66 offen offset:128 nt
  s_waitcnt vmcnt(17)
  v_mfma_f32_16x16x32_bf16 v[32:35], v[224:227], v[60:63], 0
  s_waitcnt vmcnt(16)
  v_mfma_f32_16x16x32_bf16 v[32:35], v[228:231], v[64:67], v[32:35]
  s_waitcnt vmcnt(5)
  buffer_load_dwordx4 v[104:107], v3, s[40:43], s66 offen offset:256 nt
  s_waitcnt vmcnt(16)
  v_mfma_f32_16x16x32_bf16 v[32:35], v[232:235], v[68:71], v[32:35]
  s_waitcnt vmcnt(15)
  v_mfma_f32_16x16x32_bf16 v[32:35], v[236:239], v[72:75], v[32:35]
  s_waitcnt vmcnt(5)
  buffer_load_dwordx4 v[108:111], v3, s[40:43], s66 offen offset:384 nt
  s_nop 5
  v_permlane32_swap_b32 v28, v32
  v_permlane32_swap_b32 v29, v33
  v_permlane32_swap_b32 v30, v34
  v_permlane32_swap_b32 v31, v35
  v_add_f32_dpp v12, v32, v28 row_half_mirror row_mask:0xf bank_mask:0x5
  v_add_f32_dpp v13, v33, v29 row_half_mirror row_mask:0xf bank_mask:0x5
  v_add_f32_dpp v14, v34, v30 row_half_mirror row_mask:0xf bank_mask:0x5
  v_add_f32_dpp v15, v35, v31 row_half_mirror row_mask:0xf bank_mask:0x5
  v_add_f32_dpp v12, v28, v32 row_half_mirror row_mask:0xf bank_mask:0xa
  v_add_f32_dpp v13, v29, v33 row_half_mirror row_mask:0xf bank_mask:0xa
  v_add_f32_dpp v14, v30, v34 row_half_mirror row_mask:0xf bank_mask:0xa
  v_add_f32_dpp v15, v31, v35 row_half_mirror row_mask:0xf bank_mask:0xa
  v_cvt_pk_bf16_f32 v16, v12, v13
  v_cvt_pk_bf16_f32 v17, v14, v15
  v_max3_f32 v9, v12, v13, v9
  ds_write_b64 v20, v[16:17] offset:12544
  v_max3_f32 v9, v14, v15, v9
  s_waitcnt vmcnt(15)
  v_mfma_f32_16x16x32_bf16 v[28:31], v[112:115], v[60:63], 0
  s_waitcnt vmcnt(14)
  v_mfma_f32_16x16x32_bf16 v[28:31], v[116:119], v[64:67], v[28:31]
  s_add_u32 s66, s69, 229376
  s_and_b32 s66, s66, 0xfffff
  s_add_u32 s66, s66, s64
  s_waitcnt vmcnt(5)
  buffer_load_dwordx4 v[112:115], v2, s[40:43], s66 offen offset:0 nt
  s_waitcnt vmcnt(14)
  v_mfma_f32_16x16x32_bf16 v[28:31], v[120:123], v[68:71], v[28:31]
  s_waitcnt vmcnt(13)
  v_mfma_f32_16x16x32_bf16 v[28:31], v[124:127], v[72:75], v[28:31]
  s_waitcnt vmcnt(5)
  buffer_load_dwordx4 v[116:119], v2, s[40:43], s66 offen offset:128 nt
  s_waitcnt vmcnt(13)
  v_mfma_f32_16x16x32_bf16 v[32:35], v[128:131], v[60:63], 0
  s_waitcnt vmcnt(12)
  v_mfma_f32_16x16x32_bf16 v[32:35], v[132:135], v[64:67], v[32:35]
  s_waitcnt vmcnt(5)
  buffer_load_dwordx4 v[120:123], v2, s[40:43], s66 offen offset:256 nt
  s_waitcnt vmcnt(12)
  v_mfma_f32_16x16x32_bf16 v[32:35], v[136:139], v[68:71], v[32:35]
  s_waitcnt vmcnt(11)
  v_mfma_f32_16x16x32_bf16 v[32:35], v[140:143], v[72:75], v[32:35]
  s_waitcnt vmcnt(5)
  buffer_load_dwordx4 v[124:127], v2, s[40:43], s66 offen offset:384 nt
  s_nop 5
  v_permlane32_swap_b32 v28, v32
  v_permlane32_swap_b32 v29, v33
  v_permlane32_swap_b32 v30, v34
  v_permlane32_swap_b32 v31, v35
  v_add_f32_dpp v12, v32, v28 row_half_mirror row_mask:0xf bank_mask:0x5
  v_add_f32_dpp v13, v33, v29 row_half_mirror row_mask:0xf bank_mask:0x5
  v_add_f32_dpp v14, v34, v30 row_half_mirror row_mask:0xf bank_mask:0x5
  v_add_f32_dpp v15, v35, v31 row_half_mirror row_mask:0xf bank_mask:0x5
  v_add_f32_dpp v12, v28, v32 row_half_mirror row_mask:0xf bank_mask:0xa
  v_add_f32_dpp v13, v29, v33 row_half_mirror row_mask:0xf bank_mask:0xa
  v_add_f32_dpp v14, v30, v34 row_half_mirror row_mask:0xf bank_mask:0xa
  v_add_f32_dpp v15, v31, v35 row_half_mirror row_mask:0xf bank_mask:0xa
  v_cvt_pk_bf16_f32 v16, v12, v13
  v_cvt_pk_bf16_f32 v17, v14, v15
  v_max3_f32 v9, v12, v13, v9
  ds_write_b64 v20, v[16:17] offset:12608
  v_max3_f32 v9, v14, v15, v9
  s_add_u32 s69, s69, 229376
  v_add_u32 v20, 384, v20
  s_mov_b32 s67, 12
L_kloop_1:
  s_add_u32 s65, s69, 0
  s_and_b32 s65, s65, 0xfffff
  s_add_u32 s65, s65, s64
  s_add_u32 s66, s69, 32768
  s_and_b32 s66, s66, 0xfffff
  s_add_u32 s66, s66, s64
  s_add_u32 s70, s69, 65536
  s_and_b32 s70, s70, 0xfffff
  s_add_u32 s70, s70, s64
  s_add_u32 s69, s69, 65536
  v_mfma_f32_16x16x32_bf16 v[28:31], v[80:83], v[60:63], 0
  s_waitcnt vmcnt(5)
  buffer_load_dwordx4 v[128:131], v3, s[40:43], s65 offen offset:0 nt
  v_mfma_f32_16x16x32_bf16 v[28:31], v[84:87], v[64:67], v[28:31]
  s_waitcnt vmcnt(5)
  buffer_load_dwordx4 v[132:135], v3, s[40:43], s65 offen offset:128 nt
  v_mfma_f32_16x16x32_bf16 v[28:31], v[88:91], v[68:71], v[28:31]
  s_waitcnt vmcnt(5)
  buffer_load_dwordx4 v[136:139], v3, s[40:43], s65 offen offset:256 nt
  v_mfma_f32_16x16x32_bf16 v[28:31], v[92:95], v[72:75], v[28:31]
  s_waitcnt vmcnt(5)
  buffer_load_dwordx4 v[140:143], v3, s[40:43], s65 offen offset:384 nt
  v_mfma_f32_16x16x32_bf16 v[32:35], v[96:99], v[60:63], 0
  s_waitcnt vmcnt(5)
  buffer_load_dwordx4 v[80:83], v2, s[40:43], s66 offen offset:0 nt
  v_mfma_f32_16x16x32_bf16 v[32:35], v[100:103], v[64:67], v[32:35]
  s_waitcnt vmcnt(5)
  buffer_load_dwordx4 v[84:87], v2, s[40:43], s66 offen offset:128 nt
  v_mfma_f32_16x16x32_bf16 v[32:35], v[104:107], v[68:71], v[32:35]
  s_waitcnt vmcnt(5)
  buffer_load_dwordx4 v[88:91], v2, s[40:43], s66 offen offset:256 nt
  v_mfma_f32_16x16x32_bf16 v[32:35], v[108:111], v[72:75], v[32:35]
  s_waitcnt vmcnt(5)
  buffer_load_dwordx4 v[92:95], v2, s[40:43], s66 offen offset:384 nt
  s_nop 5
  v_permlane32_swap_b32 v28, v32
  v_permlane32_swap_b32 v29, v33
  v_permlane32_swap_b32 v30, v34
  v_permlane32_swap_b32 v31, v35
  v_add_f32_dpp v12, v32, v28 row_half_mirror row_mask:0xf bank_mask:0x5
  v_add_f32_dpp v13, v33, v29 row_half_mirror row_mask:0xf bank_mask:0x5
  v_add_f32_dpp v14, v34, v30 row_half_mirror row_mask:0xf bank_mask:0x5
  v_add_f32_dpp v15, v35, v31 row_half_mirror row_mask:0xf bank_mask:0x5
  v_add_f32_dpp v12, v28, v32 row_half_mirror row_mask:0xf bank_mask:0xa
  v_add_f32_dpp v13, v29, v33 row_half_mirror row_mask:0xf bank_mask:0xa
  v_add_f32_dpp v14, v30, v34 row_half_mirror row_mask:0xf bank_mask:0xa
  v_add_f32_dpp v15, v31, v35 row_half_mirror row_mask:0xf bank_mask:0xa
  v_cvt_pk_bf16_f32 v16, v12, v13
  v_cvt_pk_bf16_f32 v17, v14, v15
  v_max3_f32 v9, v12, v13, v9
  ds_write_b64 v20, v[16:17] offset:12288
  v_max3_f32 v9, v14, v15, v9
  v_mfma_f32_16x16x32_bf16 v[28:31], v[112:115], v[60:63], 0
  s_waitcnt vmcnt(5)
  buffer_load_dwordx4 v[96:99], v3, s[40:43], s66 offen offset:0 nt
  v_mfma_f32_16x16x32_bf16 v[28:31], v[116:119], v[64:67], v[28:31]
  s_waitcnt vmcnt(5)
  buffer_load_dwordx4 v[100:103], v3, s[40:43], s66 offen offset:128 nt
  v_mfma_f32_16x16x32_bf16 v[28:31], v[120:123], v[68:71], v[28:31]
  s_waitcnt vmcnt(5)
  buffer_load_dwordx4 v[104:107], v3, s[40:43], s66 offen offset:256 nt
  v_mfma_f32_16x16x32_bf16 v[28:31], v[124:127], v[72:75], v[28:31]
  s_waitcnt vmcnt(5)
  buffer_load_dwordx4 v[108:111], v3, s[40:43], s66 offen offset:384 nt
  v_mfma_f32_16x16x32_bf16 v[32:35], v[128:131], v[60:63], 0
  s_waitcnt vmcnt(5)
  buffer_load_dwordx4 v[112:115], v2, s[40:43], s70 offen offset:0 nt
  v_mfma_f32_16x16x32_bf16 v[32:35], v[132:135], v[64:67], v[32:35]
  s_waitcnt vmcnt(5)
  buffer_load_dwordx4 v[116:119], v2, s[40:43], s70 offen offset:128 nt
  v_mfma_f32_16x16x32_bf16 v[32:35], v[136:139], v[68:71], v[32:35]
  s_waitcnt vmcnt(5)
  buffer_load_dwordx4 v[120:123], v2, s[40:43], s70 offen offset:256 nt
  v_mfma_f32_16x16x32_bf16 v[32:35], v[140:143], v[72:75], v[32:35]
  s_waitcnt vmcnt(5)
  buffer_load_dwordx4 v[124:127], v2, s[40:43], s70 offen offset:384 nt
  s_nop 5
  v_permlane32_swap_b32 v28, v32
  v_permlane32_swap_b32 v29, v33
  v_permlane32_swap_b32 v30, v34
  v_permlane32_swap_b32 v31, v35
  v_add_f32_dpp v12, v32, v28 row_half_mirror row_mask:0xf bank_mask:0x5
  v_add_f32_dpp v13, v33, v29 row_half_mirror row_mask:0xf bank_mask:0x5
  v_add_f32_dpp v14, v34, v30 row_half_mirror row_mask:0xf bank_mask:0x5
  v_add_f32_dpp v15, v35, v31 row_half_mirror row_mask:0xf bank_mask:0x5
  v_add_f32_dpp v12, v28, v32 row_half_mirror row_mask:0xf bank_mask:0xa
  v_add_f32_dpp v13, v29, v33 row_half_mirror row_mask:0xf bank_mask:0xa
  v_add_f32_dpp v14, v30, v34 row_half_mirror row_mask:0xf bank_mask:0xa
  v_add_f32_dpp v15, v31, v35 row_half_mirror row_mask:0xf bank_mask:0xa
  v_cvt_pk_bf16_f32 v16, v12, v13
  v_cvt_pk_bf16_f32 v17, v14, v15
  v_max3_f32 v9, v12, v13, v9
  ds_write_b64 v20, v[16:17] offset:12352
  v_max3_f32 v9, v14, v15, v9
  v_add_u32 v20, 128, v20
  s_sub_u32 s67, s67, 1
  s_cmp_lg_u32 s67, 0
  s_cbranch_scc1 L_kloop_1
  s_add_u32 s65, s69, 0
  s_and_b32 s65, s65, 0xfffff
  s_add_u32 s65, s65, s64
  s_add_u32 s66, s69, 32768
  s_and_b32 s66, s66, 0xfffff
  s_add_u32 s66, s66, s64
  s_add_u32 s70, s69, 65536
  s_and_b32 s70, s70, 0xfffff
  s_add_u32 s70, s70, s64
  s_add_u32 s69, s69, 65536
  v_mfma_f32_16x16x32_bf16 v[28:31], v[80:83], v[60:63], 0
  s_waitcnt vmcnt(5)
  buffer_load_dwordx4 v[128:131], v3, s[40:43], s65 offen offset:0 nt
  v_mfma_f32_16x16x32_bf16 v[28:31], v[84:87], v[64:67], v[28:31]
  s_waitcnt vmcnt(5)
  buffer_load_dwordx4 v[132:135], v3, s[40:43], s65 offen offset:128 nt
  v_mfma_f32_16x16x32_bf16 v[28:31], v[88:91], v[68:71], v[28:31]
  s_waitcnt vmcnt(5)
  buffer_load_dwordx4 v[136:139], v3, s[40:43], s65 offen offset:256 nt
  v_mfma_f32_16x16x32_bf16 v[28:31], v[92:95], v[72:75], v[28:31]
  s_waitcnt vmcnt(5)
  buffer_load_dwordx4 v[140:143], v3, s[40:43], s65 offen offset:384 nt
  v_mfma_f32_16x16x32_bf16 v[32:35], v[96:99], v[60:63], 0
  s_waitcnt vmcnt(5)
  buffer_load_dwordx4 v[80:83], v4, s[44:47], s66 offen offset:0 nt
  v_mfma_f32_16x16x32_bf16 v[32:35], v[100:103], v[64:67], v[32:35]
  s_waitcnt vmcnt(5)
  buffer_load_dwordx4 v[84:87], v4, s[44:47], s66 offen offset:256 nt
  v_mfma_f32_16x16x32_bf16 v[32:35], v[104:107], v[68:71], v[32:35]
  s_waitcnt vmcnt(5)
  buffer_load_dwordx4 v[88:91], v4, s[44:47], s66 offen offset:512 nt
  v_mfma_f32_16x16x32_bf16 v[32:35], v[108:111], v[72:75], v[32:35]
  s_waitcnt vmcnt(5)
  buffer_load_dwordx4 v[92:95], v4, s[44:47], s66 offen offset:768 nt
  s_nop 5
  v_permlane32_swap_b32 v28, v32
  v_permlane32_swap_b32 v29, v33
  v_permlane32_swap_b32 v30, v34
  v_permlane32_swap_b32 v31, v35
  v_add_f32_dpp v12, v32, v28 row_half_mirror row_mask:0xf bank_mask:0x5
  v_add_f32_dpp v13, v33, v29 row_half_mirror row_mask:0xf bank_mask:0x5
  v_add_f32_dpp v14, v34, v30 row_half_mirror row_mask:0xf bank_mask:0x5
  v_add_f32_dpp v15, v35, v31 row_half_mirror row_mask:0xf bank_mask:0x5
  v_add_f32_dpp v12, v28, v32 row_half_mirror row_mask:0xf bank_mask:0xa
  v_add_f32_dpp v13, v29, v33 row_half_mirror row_mask:0xf bank_mask:0xa
  v_add_f32_dpp v14, v30, v34 row_half_mirror row_mask:0xf bank_mask:0xa
  v_add_f32_dpp v15, v31, v35 row_half_mirror row_mask:0xf bank_mask:0xa
  v_cvt_pk_bf16_f32 v16, v12, v13
  v_cvt_pk_bf16_f32 v17, v14, v15
  v_max3_f32 v9, v12, v13, v9
  ds_write_b64 v20, v[16:17] offset:12288
  v_max3_f32 v9, v14, v15, v9
  v_mfma_f32_16x16x32_bf16 v[28:31], v[112:115], v[60:63], 0
  s_waitcnt vmcnt(5)
  buffer_load_dwordx4 v[96:99], v4, s[44:47], s66 offen offset:1024 nt
  v_mfma_f32_16x16x32_bf16 v[28:31], v[116:119], v[64:67], v[28:31]
  s_waitcnt vmcnt(5)
  buffer_load_dwordx4 v[100:103], v4, s[44:47], s66 offen offset:1280 nt
  v_mfma_f32_16x16x32_bf16 v[28:31], v[120:123], v[68:71], v[28:31]
  s_waitcnt vmcnt(5)
  buffer_load_dwordx4 v[104:107], v4, s[44:47], s66 offen offset:1536 nt
  v_mfma_f32_16x16x32_bf16 v[28:31], v[124:127], v[72:75], v[28:31]
  s_waitcnt vmcnt(5)
  buffer_load_dwordx4 v[108:111], v4, s[44:47], s66 offen offset:1792 nt
  v_mfma_f32_16x16x32_bf16 v[32:35], v[128:131], v[60:63], 0
  s_waitcnt vmcnt(5)
  buffer_load_dwordx4 v[112:115], v4, s[44:47], s70 offen offset:0 nt
  v_mfma_f32_16x16x32_bf16 v[32:35], v[132:135], v[64:67], v[32:35]
  s_waitcnt vmcnt(5)
  buffer_load_dwordx4 v[116:119], v4, s[44:47], s70 offen offset:256 nt
  v_mfma_f32_16x16x32_bf16 v[32:35], v[136:139], v[68:71], v[32:35]
  s_waitcnt vmcnt(5)
  buffer_load_dwordx4 v[120:123], v4, s[44:47], s70 offen offset:512 nt
  v_mfma_f32_16x16x32_bf16 v[32:35], v[140:143], v[72:75], v[32:35]
  s_waitcnt vmcnt(5)
  buffer_load_dwordx4 v[124:127], v4, s[44:47], s70 offen offset:768 nt
  s_nop 5
  v_permlane32_swap_b32 v28, v32
  v_permlane32_swap_b32 v29, v33
  v_permlane32_swap_b32 v30, v34
  v_permlane32_swap_b32 v31, v35
  v_add_f32_dpp v12, v32, v28 row_half_mirror row_mask:0xf bank_mask:0x5
  v_add_f32_dpp v13, v33, v29 row_half_mirror row_mask:0xf bank_mask:0x5
  v_add_f32_dpp v14, v34, v30 row_half_mirror row_mask:0xf bank_mask:0x5
  v_add_f32_dpp v15, v35, v31 row_half_mirror row_mask:0xf bank_mask:0x5
  v_add_f32_dpp v12, v28, v32 row_half_mirror row_mask:0xf bank_mask:0xa
  v_add_f32_dpp v13, v29, v33 row_half_mirror row_mask:0xf bank_mask:0xa
  v_add_f32_dpp v14, v30, v34 row_half_mirror row_mask:0xf bank_mask:0xa
  v_add_f32_dpp v15, v31, v35 row_half_mirror row_mask:0xf bank_mask:0xa
  v_cvt_pk_bf16_f32 v16, v12, v13
  v_cvt_pk_bf16_f32 v17, v14, v15
  v_max3_f32 v9, v12, v13, v9
  ds_write_b64 v20, v[16:17] offset:12352
  v_max3_f32 v9, v14, v15, v9
  ds_read_b64 v[16:17], v21 offset:12288
  v_mov_b32 v19, v9
  s_nop 1
  v_permlane16_swap_b32 v9, v19
  v_max_f32 v9, v9, v19
  v_mov_b32 v19, v9
  s_nop 1
  v_permlane32_swap_b32 v9, v19
  v_max_f32 v9, v9, v19
  v_cvt_pk_bf16_f32 v9, v9, v9
  v_lshlrev_b32 v9, 16, v9
  v_mul_f32 v11, s10, v9
  v_sub_f32 v11, 0, v11
  s_mov_b32 s67, 16
L_vloop_2:
  s_add_u32 s65, s69, 0
  s_and_b32 s65, s65, 0xfffff
  s_add_u32 s65, s65, s64
  s_add_u32 s66, s69, 32768
  s_and_b32 s66, s66, 0xfffff
  s_add_u32 s66, s66, s64
  s_add_u32 s70, s69, 65536
  s_and_b32 s70, s70, 0xfffff
  s_add_u32 s70, s70, s64
  s_add_u32 s69, s69, 65536
  s_cmp_eq_u32 s67, 1
  s_cselect_b32 s66, 0x80000000, s66
  s_cselect_b32 s70, 0x80000000, s70
  v_mov_b32 v23, s67
  ds_write_b32 v0, v23 offset:160
  s_waitcnt lgkmcnt(0)
  ds_read_b64 v[18:19], v21 offset:12352
  v_lshlrev_b32 v12, 16, v16
  v_and_b32 v13, 0xffff0000, v16
  v_lshlrev_b32 v14, 16, v17
  v_and_b32 v15, 0xffff0000, v17
  v_fma_f32 v24, v12, s10, v11
  v_fma_f32 v25, v13, s10, v11
  v_fma_f32 v26, v14, s10, v11
  v_fma_f32 v27, v15, s10, v11
  v_exp_f32 v24, v24
  v_exp_f32 v25, v25
  v_exp_f32 v26, v26
  v_exp_f32 v27, v27
  v_cvt_pk_bf16_f32 v12, v24, v24
  v_cvt_pk_bf16_f32 v13, v25, v25
  v_cvt_pk_bf16_f32 v14, v26, v26
  v_cvt_pk_bf16_f32 v15, v27, v27
  s_waitcnt vmcnt(5)
  buffer_load_dwordx4 v[128:131], v4, s[44:47], s65 offen offset:1024 nt
  v_and_b32 v44, v12, v5
  v_and_b32 v45, v12, v6
  v_and_b32 v46, v12, v7
  v_and_b32 v47, v12, v8
  v_add_f32 v24, v24, v25
  v_add_f32 v26, v26, v27
  v_and_b32 v48, v13, v5
  v_and_b32 v49, v13, v6
  v_and_b32 v50, v13, v7
  v_and_b32 v51, v13, v8
  v_and_b32 v52, v14, v5
  v_and_b32 v53, v14, v6
  v_and_b32 v54, v14, v7
  v_and_b32 v55, v14, v8
  v_and_b32 v56, v15, v5
  v_and_b32 v57, v15, v6
  v_and_b32 v58, v15, v7
  v_and_b32 v59, v15, v8
  v_add_f32 v24, v24, v26
  v_add_f32 v10, v10, v24
  v_mfma_f32_16x16x32_bf16 v[36:39], v[44:47], v[80:83], v[36:39]
  s_waitcnt vmcnt(5)
  buffer_load_dwordx4 v[132:135], v4, s[44:47], s65 offen offset:1280 nt
  v_mfma_f32_16x16x32_bf16 v[40:43], v[44:47], v[84:87], v[40:43]
  s_waitcnt vmcnt(5)
  buffer_load_dwordx4 v[136:139], v4, s[44:47], s65 offen offset:1536 nt
  v_mfma_f32_16x16x32_bf16 v[36:39], v[48:51], v[88:91], v[36:39]
  s_waitcnt vmcnt(5)
  buffer_load_dwordx4 v[140:143], v4, s[44:47], s65 offen offset:1792 nt
  v_mfma_f32_16x16x32_bf16 v[40:43], v[48:51], v[92:95], v[40:43]
  s_waitcnt vmcnt(5)
  buffer_load_dwordx4 v[80:83], v4, s[44:47], s66 offen offset:0 nt
  v_mfma_f32_16x16x32_bf16 v[36:39], v[52:55], v[96:99], v[36:39]
  s_waitcnt vmcnt(5)
  buffer_load_dwordx4 v[84:87], v4, s[44:47], s66 offen offset:256 nt
  v_mfma_f32_16x16x32_bf16 v[40:43], v[52:55], v[100:103], v[40:43]
  s_waitcnt vmcnt(5)
  buffer_load_dwordx4 v[88:91], v4, s[44:47], s66 offen offset:512 nt
  v_mfma_f32_16x16x32_bf16 v[36:39], v[56:59], v[104:107], v[36:39]
  s_waitcnt vmcnt(5)
  buffer_load_dwordx4 v[92:95], v4, s[44:47], s66 offen offset:768 nt
  v_mfma_f32_16x16x32_bf16 v[40:43], v[56:59], v[108:111], v[40:43]
  s_waitcnt lgkmcnt(0)
  ds_read_b64 v[16:17], v21 offset:12416
  v_lshlrev_b32 v12, 16, v18
  v_and_b32 v13, 0xffff0000, v18
  v_lshlrev_b32 v14, 16, v19
  v_and_b32 v15, 0xffff0000, v19
  v_fma_f32 v24, v12, s10, v11
  v_fma_f32 v25, v13, s10, v11
  v_fma_f32 v26, v14, s10, v11
  v_fma_f32 v27, v15, s10, v11
  v_exp_f32 v24, v24
  v_exp_f32 v25, v25
  v_exp_f32 v26, v26
  v_exp_f32 v27, v27
  v_cvt_pk_bf16_f32 v12, v24, v24
  v_cvt_pk_bf16_f32 v13, v25, v25
  v_cvt_pk_bf16_f32 v14, v26, v26
  v_cvt_pk_bf16_f32 v15, v27, v27
  s_waitcnt vmcnt(5)
  buffer_load_dwordx4 v[96:99], v4, s[44:47], s66 offen offset:1024 nt
  v_and_b32 v44, v12, v5
  v_and_b32 v45, v12, v6
  v_and_b32 v46, v12, v7
  v_and_b32 v47, v12, v8
  v_add_f32 v24, v24, v25
  v_add_f32 v26, v26, v27
  v_and_b32 v48, v13, v5
  v_and_b32 v49, v13, v6
  v_and_b32 v50, v13, v7
  v_and_b32 v51, v13, v8
  v_and_b32 v52, v14, v5
  v_and_b32 v53, v14, v6
  v_and_b32 v54, v14, v7
  v_and_b32 v55, v14, v8
  v_and_b32 v56, v15, v5
  v_and_b32 v57, v15, v6
  v_and_b32 v58, v15, v7
  v_and_b32 v59, v15, v8
  v_add_f32 v24, v24, v26
  v_add_f32 v10, v10, v24
  v_mfma_f32_16x16x32_bf16 v[36:39], v[44:47], v[112:115], v[36:39]
  s_waitcnt vmcnt(5)
  buffer_load_dwordx4 v[100:103], v4, s[44:47], s66 offen offset:1280 nt
  v_mfma_f32_16x16x32_bf16 v[40:43], v[44:47], v[116:119], v[40:43]
  s_waitcnt vmcnt(5)
  buffer_load_dwordx4 v[104:107], v4, s[44:47], s66 offen offset:1536 nt
  v_mfma_f32_16x16x32_bf16 v[36:39], v[48:51], v[120:123], v[36:39]
  s_waitcnt vmcnt(5)
  buffer_load_dwordx4 v[108:111], v4, s[44:47], s66 offen offset:1792 nt
  v_mfma_f32_16x16x32_bf16 v[40:43], v[48:51], v[124:127], v[40:43]
  s_waitcnt vmcnt(5)
  buffer_load_dwordx4 v[112:115], v4, s[44:47], s70 offen offset:0 nt
  v_mfma_f32_16x16x32_bf16 v[36:39], v[52:55], v[128:131], v[36:39]
  s_waitcnt vmcnt(5)
  buffer_load_dwordx4 v[116:119], v4, s[44:47], s70 offen offset:256 nt
  v_mfma_f32_16x16x32_bf16 v[40:43], v[52:55], v[132:135], v[40:43]
  s_waitcnt vmcnt(5)
  buffer_load_dwordx4 v[120:123], v4, s[44:47], s70 offen offset:512 nt
  v_mfma_f32_16x16x32_bf16 v[36:39], v[56:59], v[136:139], v[36:39]
  s_waitcnt vmcnt(5)
  buffer_load_dwordx4 v[124:127], v4, s[44:47], s70 offen offset:768 nt
  v_mfma_f32_16x16x32_bf16 v[40:43], v[56:59], v[140:143], v[40:43]
  v_add_u32 v21, 128, v21
  s_sub_u32 s67, s67, 1
  s_cmp_lg_u32 s67, 0
  s_cbranch_scc1 L_vloop_2
  s_waitcnt lgkmcnt(0)
  v_mov_b32 v19, v10
  s_nop 1
  v_permlane16_swap_b32 v10, v19
  v_add_f32 v10, v10, v19
  v_mov_b32 v19, v10
  s_nop 1
  v_permlane32_swap_b32 v10, v19
  v_add_f32 v10, v10, v19
  ds_write_b128 v76, v[36:39] offset:12288
  ds_write_b128 v76, v[40:43] offset:12800
  s_mov_b64 exec, 0x101
  ds_write2_b32 v77, v11, v10 offset0:0 offset1:1
  s_mov_b64 exec, 1
  ds_add_rtn_u32 v22, v79, v78 offset:132
  s_mov_b64 exec, -1
  s_waitcnt lgkmcnt(0)
  v_readfirstlane_b32 s64, v22
  s_nop 0
  s_cmp_eq_u32 s64, 3
  s_cbranch_scc1 L_slast_3
  s_endpgm
L_slast_3:
  s_waitcnt vmcnt(0)
L_sfinal:
  v_mov_b32 v20, 0
  v_lshlrev_b32 v22, 4, v1
  ds_read_b128 v[24:27], v20 offset:0
  ds_read_b128 v[28:31], v20 offset:16
  ds_read_b128 v[32:35], v20 offset:32
  ds_read_b128 v[36:39], v20 offset:48
  ds_read_b128 v[80:83], v22 offset:12288
  ds_read_b128 v[84:87], v22 offset:14336
  ds_read_b128 v[88:91], v22 offset:16384
  ds_read_b128 v[92:95], v22 offset:18432
  ds_read_b128 v[96:99], v22 offset:13312
  ds_read_b128 v[100:103], v22 offset:15360
  ds_read_b128 v[104:107], v22 offset:17408
  ds_read_b128 v[108:111], v22 offset:19456
  s_and_b32 s96, s9, 0x3f
  v_mov_b32 v21, 0xffffffc0
  s_waitcnt lgkmcnt(8)
  v_min3_f32 v40, v24, v28, v32
  v_min_f32 v40, v40, v36
  v_min3_f32 v41, v26, v30, v34
  v_min_f32 v41, v41, v38
  v_sub_f32 v44, v40, v24
  v_sub_f32 v45, v40, v28
  v_sub_f32 v46, v40, v32
  v_sub_f32 v47, v40, v36
  v_sub_f32 v48, v41, v26
  v_sub_f32 v49, v41, v30
  v_sub_f32 v50, v41, v34
  v_sub_f32 v51, v41, v38
  v_exp_f32 v44, v44
  v_exp_f32 v45, v45
  v_exp_f32 v46, v46
  v_exp_f32 v47, v47
  v_exp_f32 v48, v48
  v_exp_f32 v49, v49
  v_exp_f32 v50, v50
  v_exp_f32 v51, v51
  v_mul_f32 v42, v44, v25
  v_mul_f32 v43, v48, v27
  v_fmac_f32 v42, v45, v29
  v_fmac_f32 v43, v49, v31
  v_fmac_f32 v42, v46, v33
  v_fmac_f32 v43, v50, v35
  v_fmac_f32 v42, v47, v37
  v_fmac_f32 v43, v51, v39
  v_rcp_f32 v52, v42
  v_rcp_f32 v53, v43
  v_log_f32 v54, v42
  v_log_f32 v55, v43
  v_mul_f32 v44, v44, v52
  v_mul_f32 v45, v45, v52
  v_mul_f32 v46, v46, v52
  v_mul_f32 v47, v47, v52
  v_mul_f32 v48, v48, v53
  v_mul_f32 v49, v49, v53
  v_mul_f32 v50, v50, v53
  v_mul_f32 v51, v51, v53
  v_sub_f32 v54, v54, v40
  v_sub_f32 v55, v55, v41
  s_lshl_b32 s64, s2, 11
  s_add_u32 s64, s64, 262144
  s_waitcnt lgkmcnt(4)
  v_mul_f32 v56, v44, v80
  v_mul_f32 v57, v44, v81
  v_mul_f32 v58, v44, v82
  v_mul_f32 v59, v44, v83
  v_fmac_f32 v56, v45, v84
  v_fmac_f32 v57, v45, v85
  v_fmac_f32 v58, v45, v86
  v_fmac_f32 v59, v45, v87
  v_fmac_f32 v56, v46, v88
  v_fmac_f32 v57, v46, v89
  v_fmac_f32 v58, v46, v90
  v_fmac_f32 v59, v46, v91
  v_fmac_f32 v56, v47, v92
  v_fmac_f32 v57, v47, v93
  v_fmac_f32 v58, v47, v94
  v_fmac_f32 v59, v47, v95
  v_and_or_b32 v56, v56, v21, s96
  v_and_or_b32 v57, v57, v21, s96
  v_and_or_b32 v58, v58, v21, s96
  v_and_or_b32 v59, v59, v21, s96
  s_waitcnt lgkmcnt(0)
  v_mul_f32 v60, v48, v96
  v_mul_f32 v61, v48, v97
  v_mul_f32 v62, v48, v98
  v_mul_f32 v63, v48, v99
  v_fmac_f32 v60, v49, v100
  v_fmac_f32 v61, v49, v101
  v_fmac_f32 v62, v49, v102
  v_fmac_f32 v63, v49, v103
  v_fmac_f32 v60, v50, v104
  v_fmac_f32 v61, v50, v105
  v_fmac_f32 v62, v50, v106
  v_fmac_f32 v63, v50, v107
  v_fmac_f32 v60, v51, v108
  v_fmac_f32 v61, v51, v109
  v_fmac_f32 v62, v51, v110
  v_fmac_f32 v63, v51, v111
  v_and_or_b32 v60, v60, v21, s96
  v_and_or_b32 v61, v61, v21, s96
  v_and_or_b32 v62, v62, v21, s96
  v_and_or_b32 v63, v63, v21, s96
  v_cmp_eq_u32 vcc, 1, v1
  s_nop 1
  v_cndmask_b32 v72, v54, v55, vcc
  v_mov_b32 v73, s9
  v_lshlrev_b32 v23, 11, v1
  s_lshl_b32 s65, s2, 3
  s_add_u32 s65, s65, 73728
  s_cmp_eq_u32 s68, 1
  s_cbranch_scc1 L_sfinal_back
  buffer_store_dwordx4 v[56:59], v22, s[48:51], s64 offen offset:0 sc1
  buffer_store_dwordx4 v[60:63], v22, s[48:51], s64 offen offset:1024 sc1
  s_mov_b64 exec, 3
  buffer_store_dwordx2 v[72:73], v23, s[48:51], s65 offen sc1
  ds_add_u32 v79, v78 offset:132
  s_endpgm
L_hpath:
  s_lshr_b32 s4, s2, 4
  s_and_b32 s5, s2, 15
  s_lshr_b32 s6, s2, 7
  s_and_b32 s7, s4, 7
  s_mov_b32 s11, 300000
  s_waitcnt lgkmcnt(0)
  s_mov_b32 s48, s38
  s_mov_b32 s49, s39
  s_mov_b32 s50, 4194304
  s_mov_b32 s51, 0x20000
  s_mov_b32 s56, s16
  s_mov_b32 s57, s17
  s_mov_b32 s58, 1792
  s_mov_b32 s59, 0x20000
  s_setprio 2
  s_cmp_lg_u32 s8, 0
  s_cbranch_scc1 L_hnq
  v_lshlrev_b32 v8, 4, v1
  v_cmp_gt_u32 s[70:71], 56, v1
  v_mov_b32 v9, 0x10000
  s_nop 0
  v_cndmask_b32 v8, v9, v8, s[70:71]
  buffer_load_dwordx4 v[12:15], v8, s[56:59], 0 offen
  buffer_load_dwordx4 v[16:19], v8, s[56:59], 0 offen offset:896
  buffer_load_dword v10, off, s[48:51], 0 offset:0 sc1
  s_and_b32 s12, s5, 3
  s_lshr_b32 s13, s5, 2
  s_lshl_b32 s64, s6, 2
  s_add_u32 s13, s13, s64
  s_mul_i32 s64, s12, 917504
  s_lshl_b32 s65, s7, 10
  s_add_u32 s64, s64, s65
  s_lshl_b32 s65, s13, 7
  s_add_u32 s64, s64, s65
  s_mov_b32 s52, s22
  s_mov_b32 s53, s23
  s_mov_b32 s54, 3670016
  s_mov_b32 s55, 0x20000
  v_lshrrev_b32 v20, 3, v1
  v_mul_u32_u24 v20, 8192, v20
  v_and_b32 v21, 7, v1
  v_lshl_add_u32 v20, v21, 4, v20
  s_mov_b32 m0, 20480
  s_nop 0
  buffer_load_dwordx4 v20, s[52:55], s64 offen nt lds
  s_mov_b32 m0, 21504
  s_add_u32 s64, s64, 65536
  buffer_load_dwordx4 v20, s[52:55], s64 offen nt lds
  s_mov_b32 m0, 22528
  s_add_u32 s64, s64, 65536
  buffer_load_dwordx4 v20, s[52:55], s64 offen nt lds
  s_mov_b32 m0, 23552
  s_add_u32 s64, s64, 65536
  buffer_load_dwordx4 v20, s[52:55], s64 offen nt lds
  s_mov_b32 m0, 24576
  s_add_u32 s64, s64, 65536
  buffer_load_dwordx4 v20, s[52:55], s64 offen nt lds
  s_mov_b32 m0, 25600
  s_add_u32 s64, s64, 65536
  buffer_load_dwordx4 v20, s[52:55], s64 offen nt lds
  s_mov_b32 m0, 26624
  s_add_u32 s64, s64, 65536
  buffer_load_dwordx4 v20, s[52:55], s64 offen nt lds
  s_mov_b32 m0, 27648
  s_add_u32 s64, s64, 65536
  buffer_load_dwordx4 v20, s[52:55], s64 offen nt lds
  s_mov_b32 m0, 28672
  s_add_u32 s64, s64, 65536
  buffer_load_dwordx4 v20, s[52:55], s64 offen nt lds
  s_mov_b32 m0, 29696
  s_add_u32 s64, s64, 65536
  buffer_load_dwordx4 v20, s[52:55], s64 offen nt lds
  s_mov_b32 m0, 30720
  s_add_u32 s64, s64, 65536
  buffer_load_dwordx4 v20, s[52:55], s64 offen nt lds
  s_mov_b32 m0, 31744
  s_add_u32 s64, s64, 65536
  buffer_load_dwordx4 v20, s[52:55], s64 offen nt lds
  s_mov_b32 m0, 32768
  s_add_u32 s64, s64, 65536
  buffer_load_dwordx4 v20, s[52:55], s64 offen nt lds
  s_mov_b32 m0, 33792
  s_add_u32 s64, s64, 65536
  buffer_load_dwordx4 v20, s[52:55], s64 offen nt lds
  v_and_b32 v4, 15, v1
  v_lshrrev_b32 v5, 4, v1
  v_lshrrev_b32 v6, 2, v4
  v_lshl_add_u32 v6, v5, 3, v6
  v_and_b32 v7, 3, v4
  v_lshlrev_b32 v7, 3, v7
  v_and_b32 v8, 1, v1
  v_mul_u32_u24 v8, 1056, v8
  v_lshl_add_u32 v3, v5, 4, v8
  v_mov_b32 v20, 0
  v_mov_b32 v21, 0
  v_mov_b32 v21, 0x7fff
  ds_write_b64 v20, v[20:21] offset:136
  v_mov_b32 v21, 0
  ds_write_b64 v20, v[20:21] offset:144
  ds_write_b32 v20, v20 offset:132
  ds_write_b32 v20, v20 offset:156
  v_mov_b32 v21, 0x7fff
  ds_write_b32 v20, v21 offset:160
  s_waitcnt vmcnt(15)
  v_lshlrev_b32 v24, 16, v12
  v_and_b32 v25, 0xffff0000, v12
  v_lshlrev_b32 v26, 16, v13
  v_and_b32 v27, 0xffff0000, v13
  v_lshlrev_b32 v28, 16, v14
  v_and_b32 v29, 0xffff0000, v14
  v_lshlrev_b32 v30, 16, v15
  v_and_b32 v31, 0xffff0000, v15
  v_lshlrev_b32 v32, 16, v16
  v_and_b32 v33, 0xffff0000, v16
  v_lshlrev_b32 v34, 16, v17
  v_and_b32 v35, 0xffff0000, v17
  v_lshlrev_b32 v36, 16, v18
  v_and_b32 v37, 0xffff0000, v18
  v_lshlrev_b32 v38, 16, v19
  v_and_b32 v39, 0xffff0000, v19
  v_add_f32 v40, v24, v25
  v_add_f32 v40, v40, v26
  v_add_f32 v40, v40, v27
  v_add_f32 v40, v40, v28
  v_add_f32 v40, v40, v29
  v_add_f32 v40, v40, v30
  v_add_f32 v40, v40, v31
  v_add_f32 v41, v32, v33
  v_add_f32 v41, v41, v34
  v_add_f32 v41, v41, v35
  v_add_f32 v41, v41, v36
  v_add_f32 v41, v41, v37
  v_add_f32 v41, v41, v38
  v_add_f32 v41, v41, v39
  v_add_f32_dpp v40, v40, v40 quad_perm:[1,0,3,2] row_mask:0xf bank_mask:0xf
  s_nop 0
  v_add_f32_dpp v41, v41, v41 quad_perm:[1,0,3,2] row_mask:0xf bank_mask:0xf
  v_add_f32_dpp v40, v40, v40 quad_perm:[2,3,0,1] row_mask:0xf bank_mask:0xf
  s_nop 0
  v_add_f32_dpp v41, v41, v41 quad_perm:[2,3,0,1] row_mask:0xf bank_mask:0xf
  v_add_f32_dpp v40, v40, v40 row_half_mirror row_mask:0xf bank_mask:0xf
  s_nop 0
  v_add_f32_dpp v41, v41, v41 row_half_mirror row_mask:0xf bank_mask:0xf
  v_add_f32_dpp v40, v40, v40 row_mirror row_mask:0xf bank_mask:0xf
  s_nop 0
  v_add_f32_dpp v41, v41, v41 row_mirror row_mask:0xf bank_mask:0xf
  v_add_f32_dpp v40, v40, v40 row_bcast:15 row_mask:0xa bank_mask:0xf
  s_nop 0
  v_add_f32_dpp v41, v41, v41 row_bcast:15 row_mask:0xa bank_mask:0xf
  v_add_f32_dpp v40, v40, v40 row_bcast:31 row_mask:0xc bank_mask:0xf
  s_nop 0
  v_add_f32_dpp v41, v41, v41 row_bcast:31 row_mask:0xc bank_mask:0xf
  v_readlane_b32 s64, v40, 63
  v_readlane_b32 s65, v41, 63
  v_mov_b32 v42, 0x3b124925
  v_mul_f32 v42, s64, v42
  v_mov_b32 v43, 0x3b124925
  v_mul_f32 v43, s65, v43
  v_sub_f32 v44, v24, v42
  v_mul_f32 v40, v44, v44
  v_sub_f32 v44, v25, v42
  v_fmac_f32 v40, v44, v44
  v_sub_f32 v44, v26, v42
  v_fmac_f32 v40, v44, v44
  v_sub_f32 v44, v27, v42
  v_fmac_f32 v40, v44, v44
  v_sub_f32 v44, v28, v42
  v_fmac_f32 v40, v44, v44
  v_sub_f32 v44, v29, v42
  v_fmac_f32 v40, v44, v44
  v_sub_f32 v44, v30, v42
  v_fmac_f32 v40, v44, v44
  v_sub_f32 v44, v31, v42
  v_fmac_f32 v40, v44, v44
  v_cndmask_b32 v40, 0, v40, s[70:71]
  v_sub_f32 v44, v32, v43
  v_mul_f32 v41, v44, v44
  v_sub_f32 v44, v33, v43
  v_fmac_f32 v41, v44, v44
  v_sub_f32 v44, v34, v43
  v_fmac_f32 v41, v44, v44
  v_sub_f32 v44, v35, v43
  v_fmac_f32 v41, v44, v44
  v_sub_f32 v44, v36, v43
  v_fmac_f32 v41, v44, v44
  v_sub_f32 v44, v37, v43
  v_fmac_f32 v41, v44, v44
  v_sub_f32 v44, v38, v43
  v_fmac_f32 v41, v44, v44
  v_sub_f32 v44, v39, v43
  v_fmac_f32 v41, v44, v44
  v_cndmask_b32 v41, 0, v41, s[70:71]
  v_add_f32_dpp v40, v40, v40 quad_perm:[1,0,3,2] row_mask:0xf bank_mask:0xf
  s_nop 0
  v_add_f32_dpp v41, v41, v41 quad_perm:[1,0,3,2] row_mask:0xf bank_mask:0xf
  v_add_f32_dpp v40, v40, v40 quad_perm:[2,3,0,1] row_mask:0xf bank_mask:0xf
  s_nop 0
  v_add_f32_dpp v41, v41, v41 quad_perm:[2,3,0,1] row_mask:0xf bank_mask:0xf
  v_add_f32_dpp v40, v40, v40 row_half_mirror row_mask:0xf bank_mask:0xf
  s_nop 0
  v_add_f32_dpp v41, v41, v41 row_half_mirror row_mask:0xf bank_mask:0xf
  v_add_f32_dpp v40, v40, v40 row_mirror row_mask:0xf bank_mask:0xf
  s_nop 0
  v_add_f32_dpp v41, v41, v41 row_mirror row_mask:0xf bank_mask:0xf
  v_add_f32_dpp v40, v40, v40 row_bcast:15 row_mask:0xa bank_mask:0xf
  s_nop 0
  v_add_f32_dpp v41, v41, v41 row_bcast:15 row_mask:0xa bank_mask:0xf
  v_add_f32_dpp v40, v40, v40 row_bcast:31 row_mask:0xc bank_mask:0xf
  s_nop 0
  v_add_f32_dpp v41, v41, v41 row_bcast:31 row_mask:0xc bank_mask:0xf
  v_readlane_b32 s64, v40, 63
  v_readlane_b32 s65, v41, 63
  v_mov_b32 v44, 0x3b124925
  v_mul_f32 v44, s64, v44
  v_mov_b32 v45, 0x3b124925
  v_mul_f32 v45, s65, v45
  v_cvt_pk_bf16_f32 v42, v42, v42
  v_cvt_pk_bf16_f32 v43, v43, v43
  v_cvt_pk_bf16_f32 v44, v44, v44
  v_cvt_pk_bf16_f32 v45, v45, v45
  v_lshlrev_b32 v42, 16, v42
  v_lshlrev_b32 v43, 16, v43
  v_lshlrev_b32 v44, 16, v44
  v_lshlrev_b32 v45, 16, v45
  v_add_f32 v44, 0x3727c5ac, v44
  v_add_f32 v45, 0x3727c5ac, v45
  v_cvt_pk_bf16_f32 v44, v44, v44
  v_cvt_pk_bf16_f32 v45, v45, v45
  v_lshlrev_b32 v44, 16, v44
  v_lshlrev_b32 v45, 16, v45
  v_sqrt_f32 v44, v44
  v_sqrt_f32 v45, v45
  v_cvt_pk_bf16_f32 v44, v44, v44
  v_cvt_pk_bf16_f32 v45, v45, v45
  v_lshlrev_b32 v44, 16, v44
  v_lshlrev_b32 v45, 16, v45
  v_rcp_f32 v46, v44
  v_rcp_f32 v47, v45
  v_sub_f32 v24, v24, v42
  v_sub_f32 v25, v25, v42
  v_sub_f32 v26, v26, v42
  v_sub_f32 v27, v27, v42
  v_sub_f32 v28, v28, v42
  v_sub_f32 v29, v29, v42
  v_sub_f32 v30, v30, v42
  v_sub_f32 v31, v31, v42
  v_cvt_pk_bf16_f32 v12, v24, v25
  v_cvt_pk_bf16_f32 v13, v26, v27
  v_cvt_pk_bf16_f32 v14, v28, v29
  v_cvt_pk_bf16_f32 v15, v30, v31
  v_lshlrev_b32 v24, 16, v12
  v_and_b32 v25, 0xffff0000, v12
  v_lshlrev_b32 v26, 16, v13
  v_and_b32 v27, 0xffff0000, v13
  v_lshlrev_b32 v28, 16, v14
  v_and_b32 v29, 0xffff0000, v14
  v_lshlrev_b32 v30, 16, v15
  v_and_b32 v31, 0xffff0000, v15
  v_mul_f32 v24, v24, v46
  v_mul_f32 v25, v25, v46
  v_mul_f32 v26, v26, v46
  v_mul_f32 v27, v27, v46
  v_mul_f32 v28, v28, v46
  v_mul_f32 v29, v29, v46
  v_mul_f32 v30, v30, v46
  v_mul_f32 v31, v31, v46
  v_cvt_pk_bf16_f32 v12, v24, v25
  v_cvt_pk_bf16_f32 v13, v26, v27
  v_cvt_pk_bf16_f32 v14, v28, v29
  v_cvt_pk_bf16_f32 v15, v30, v31
  v_sub_f32 v32, v32, v43
  v_sub_f32 v33, v33, v43
  v_sub_f32 v34, v34, v43
  v_sub_f32 v35, v35, v43
  v_sub_f32 v36, v36, v43
  v_sub_f32 v37, v37, v43
  v_sub_f32 v38, v38, v43
  v_sub_f32 v39, v39, v43
  v_cvt_pk_bf16_f32 v16, v32, v33
  v_cvt_pk_bf16_f32 v17, v34, v35
  v_cvt_pk_bf16_f32 v18, v36, v37
  v_cvt_pk_bf16_f32 v19, v38, v39
  v_lshlrev_b32 v32, 16, v16
  v_and_b32 v33, 0xffff0000, v16
  v_lshlrev_b32 v34, 16, v17
  v_and_b32 v35, 0xffff0000, v17
  v_lshlrev_b32 v36, 16, v18
  v_and_b32 v37, 0xffff0000, v18
  v_lshlrev_b32 v38, 16, v19
  v_and_b32 v39, 0xffff0000, v19
  v_mul_f32 v32, v32, v47
  v_mul_f32 v33, v33, v47
  v_mul_f32 v34, v34, v47
  v_mul_f32 v35, v35, v47
  v_mul_f32 v36, v36, v47
  v_mul_f32 v37, v37, v47
  v_mul_f32 v38, v38, v47
  v_mul_f32 v39, v39, v47
  v_cvt_pk_bf16_f32 v16, v32, v33
  v_cvt_pk_bf16_f32 v17, v34, v35
  v_cvt_pk_bf16_f32 v18, v36, v37
  v_cvt_pk_bf16_f32 v19, v38, v39
  v_lshlrev_b32 v8, 4, v1
  s_mov_b64 exec, s[70:71]
  ds_write_b128 v8, v[12:15] offset:2048
  ds_write_b128 v8, v[16:19] offset:3104
  s_mov_b64 exec, -1
  s_waitcnt vmcnt(14)
  v_readfirstlane_b32 s64, v10
  s_nop 0
  s_add_u32 s9, s64, 0x9e3779b9
  s_and_b32 s96, s9, 0x3f
  v_mov_b32 v21, s9
  ds_write_b32 v20, v21 offset:128
  s_waitcnt vmcnt(0) lgkmcnt(0)
  s_mov_b32 s64, 20480
  v_lshl_add_u32 v2, v6, 7, v7
  v_add_u32 v2, s64, v2
  s_mul_i32 s64, s12, 224
  v_add_u32 v9, s64, v3
  ds_read_b128 v[128:131], v9 offset:2048
  ds_read_b128 v[132:135], v9 offset:2112
  ds_read_b128 v[136:139], v9 offset:2176
  ds_read_b128 v[140:143], v9 offset:2240
  ds_read_b64_tr_b16 v[64:65], v2 offset:0
  ds_read_b64_tr_b16 v[66:67], v2 offset:512
  ds_read_b64_tr_b16 v[68:69], v2 offset:4096
  ds_read_b64_tr_b16 v[70:71], v2 offset:4608
  ds_read_b64_tr_b16 v[72:73], v2 offset:8192
  ds_read_b64_tr_b16 v[74:75], v2 offset:8704
  ds_read_b64_tr_b16 v[76:77], v2 offset:12288
  ds_read_b64_tr_b16 v[78:79], v2 offset:12800
  s_waitcnt lgkmcnt(0)
  s_waitcnt lgkmcnt(0)
  ds_read_b64_tr_b16 v[80:81], v2 offset:32
  ds_read_b64_tr_b16 v[82:83], v2 offset:544
  ds_read_b64_tr_b16 v[84:85], v2 offset:4128
  ds_read_b64_tr_b16 v[86:87], v2 offset:4640
  ds_read_b64_tr_b16 v[88:89], v2 offset:8224
  ds_read_b64_tr_b16 v[90:91], v2 offset:8736
  ds_read_b64_tr_b16 v[92:93], v2 offset:12320
  ds_read_b64_tr_b16 v[94:95], v2 offset:12832
  s_waitcnt lgkmcnt(0)
  s_waitcnt lgkmcnt(0)
  ds_read_b64_tr_b16 v[96:97], v2 offset:64
  ds_read_b64_tr_b16 v[98:99], v2 offset:576
  ds_read_b64_tr_b16 v[100:101], v2 offset:4160
  ds_read_b64_tr_b16 v[102:103], v2 offset:4672
  ds_read_b64_tr_b16 v[104:105], v2 offset:8256
  ds_read_b64_tr_b16 v[106:107], v2 offset:8768
  ds_read_b64_tr_b16 v[108:109], v2 offset:12352
  ds_read_b64_tr_b16 v[110:111], v2 offset:12864
  s_waitcnt lgkmcnt(0)
  s_waitcnt lgkmcnt(0)
  ds_read_b64_tr_b16 v[112:113], v2 offset:96
  ds_read_b64_tr_b16 v[114:115], v2 offset:608
  ds_read_b64_tr_b16 v[116:117], v2 offset:4192
  ds_read_b64_tr_b16 v[118:119], v2 offset:4704
  ds_read_b64_tr_b16 v[120:121], v2 offset:8288
  ds_read_b64_tr_b16 v[122:123], v2 offset:8800
  ds_read_b64_tr_b16 v[124:125], v2 offset:12384
  ds_read_b64_tr_b16 v[126:127], v2 offset:12896
  s_waitcnt lgkmcnt(0)
  s_waitcnt lgkmcnt(0)
  v_cmp_gt_u32 vcc, 32, v1
  s_nop 1
  v_cndmask_b32 v140, 0, v140, vcc
  v_cndmask_b32 v141, 0, v141, vcc
  v_cndmask_b32 v142, 0, v142, vcc
  v_cndmask_b32 v143, 0, v143, vcc
  v_cndmask_b32 v76, 0, v76, vcc
  v_cndmask_b32 v77, 0, v77, vcc
  v_cndmask_b32 v78, 0, v78, vcc
  v_cndmask_b32 v79, 0, v79, vcc
  v_cndmask_b32 v92, 0, v92, vcc
  v_cndmask_b32 v93, 0, v93, vcc
  v_cndmask_b32 v94, 0, v94, vcc
  v_cndmask_b32 v95, 0, v95, vcc
  v_cndmask_b32 v108, 0, v108, vcc
  v_cndmask_b32 v109, 0, v109, vcc
  v_cndmask_b32 v110, 0, v110, vcc
  v_cndmask_b32 v111, 0, v111, vcc
  v_cndmask_b32 v124, 0, v124, vcc
  v_cndmask_b32 v125, 0, v125, vcc
  v_cndmask_b32 v126, 0, v126, vcc
  v_cndmask_b32 v127, 0, v127, vcc
  v_mfma_f32_16x16x32_bf16 v[144:147], v[128:131], v[64:67], 0
  v_mfma_f32_16x16x32_bf16 v[148:151], v[128:131], v[80:83], 0
  v_mfma_f32_16x16x32_bf16 v[152:155], v[128:131], v[96:99], 0
  v_mfma_f32_16x16x32_bf16 v[156:159], v[128:131], v[112:115], 0
  v_mfma_f32_16x16x32_bf16 v[144:147], v[132:135], v[68:71], v[144:147]
  v_mfma_f32_16x16x32_bf16 v[148:151], v[132:135], v[84:87], v[148:151]
  v_mfma_f32_16x16x32_bf16 v[152:155], v[132:135], v[100:103], v[152:155]
  v_mfma_f32_16x16x32_bf16 v[156:159], v[132:135], v[116:119], v[156:159]
  v_mfma_f32_16x16x32_bf16 v[144:147], v[136:139], v[72:75], v[144:147]
  v_mfma_f32_16x16x32_bf16 v[148:151], v[136:139], v[88:91], v[148:151]
  v_mfma_f32_16x16x32_bf16 v[152:155], v[136:139], v[104:107], v[152:155]
  v_mfma_f32_16x16x32_bf16 v[156:159], v[136:139], v[120:123], v[156:159]
  v_mfma_f32_16x16x32_bf16 v[144:147], v[140:143], v[76:79], v[144:147]
  v_mfma_f32_16x16x32_bf16 v[148:151], v[140:143], v[92:95], v[148:151]
  v_mfma_f32_16x16x32_bf16 v[152:155], v[140:143], v[108:111], v[152:155]
  v_mfma_f32_16x16x32_bf16 v[156:159], v[140:143], v[124:127], v[156:159]
  v_cmp_lt_u32 s[64:65], 15, v1
  v_cmp_lt_u32 s[66:67], 31, v1
  v_cmp_lt_u32 vcc, 47, v1
  v_mov_b32 v53, s9
  v_mov_b32 v55, s9
  v_lshlrev_b32 v8, 3, v1
  v_cndmask_b32 v52, v144, v148, s[64:65]
  v_cndmask_b32 v54, v145, v149, s[64:65]
  v_cndmask_b32 v52, v52, v152, s[66:67]
  v_cndmask_b32 v54, v54, v153, s[66:67]
  v_cndmask_b32 v52, v52, v156, vcc
  v_cndmask_b32 v54, v54, v157, vcc
  s_lshl_b32 s64, s7, 14
  s_lshl_b32 s65, s12, 12
  s_add_u32 s64, s64, s65
  s_lshl_b32 s65, s13, 9
  s_add_u32 s64, s64, s65
  s_add_u32 s64, s64, 1310720
  s_add_u32 s65, s64, 131072
  buffer_store_dwordx2 v[52:53], v8, s[48:51], s64 offen sc1
  buffer_store_dwordx2 v[54:55], v8, s[48:51], s65 offen sc1
  v_mov_b32 v8, 0
  v_mov_b32 v9, s9
  ds_write_b32 v8, v9 offset:152
  s_branch L_hq
L_hnq:
  buffer_load_dword v10, off, s[48:51], 0 offset:0 sc1
  v_and_b32 v4, 15, v1
  v_lshrrev_b32 v5, 4, v1
  v_lshrrev_b32 v6, 2, v4
  v_lshl_add_u32 v6, v5, 3, v6
  v_and_b32 v7, 3, v4
  v_lshlrev_b32 v7, 3, v7
  v_and_b32 v8, 1, v1
  v_mul_u32_u24 v8, 1056, v8
  v_lshl_add_u32 v3, v5, 4, v8
  s_waitcnt vmcnt(0)
  v_readfirstlane_b32 s64, v10
  s_nop 0
  s_add_u32 s9, s64, 0x9e3779b9
  s_and_b32 s96, s9, 0x3f
  v_mov_b32 v8, 0
L_lw_4:
  ds_read_b32 v9, v8 offset:152
  s_waitcnt lgkmcnt(0)
  v_readfirstlane_b32 s64, v9
  s_nop 0
  s_cmp_eq_u32 s64, s9
  s_cbranch_scc1 L_lwx_5
  s_sleep 2
  s_sub_u32 s11, s11, 1
  s_cbranch_scc0 L_lw_4
  s_branch L_hfail
L_lwx_5:
L_hq:
  v_lshlrev_b32 v8, 4, v1
  s_lshl_b32 s13, s4, 14
  s_lshl_b32 s64, s8, 10
  s_add_u32 s13, s13, s64
  s_add_u32 s13, s13, 1310720
  s_add_u32 s65, s13, 4096
  s_add_u32 s66, s13, 8192
  s_add_u32 s67, s13, 12288
  v_mov_b32 v41, v8
  v_mov_b32 v8, 0
L_lw_6:
  ds_read_b32 v9, v8 offset:176
  s_waitcnt lgkmcnt(0)
  v_readfirstlane_b32 s70, v9
  s_nop 0
  s_cmp_eq_u32 s70, 1
  s_cbranch_scc1 L_lwx_7
  s_sleep 2
  s_sub_u32 s11, s11, 1
  s_cbranch_scc0 L_lw_6
  s_branch L_hfail
L_lwx_7:
  v_mov_b32 v8, v41
  buffer_load_dwordx4 v[24:27], v8, s[48:51], s13 offen sc1
  buffer_load_dwordx4 v[28:31], v8, s[48:51], s65 offen sc1
  buffer_load_dwordx4 v[32:35], v8, s[48:51], s66 offen sc1
  buffer_load_dwordx4 v[36:39], v8, s[48:51], s67 offen sc1
L_qp_8:
  s_waitcnt vmcnt(0)
  v_bitop3_b32 v40, v25, v27, s9 bitop3:0x7e
  v_cmp_ne_u32 vcc, 0, v40
  s_cbranch_vccz L_qpx_9
  s_sleep 8
  buffer_load_dwordx4 v[24:27], v8, s[48:51], s13 offen sc1
  s_sub_u32 s11, s11, 1
  s_cbranch_scc0 L_qp_8
  s_branch L_hfail
L_qpx_9:
L_qp_10:
  s_waitcnt vmcnt(0)
  v_bitop3_b32 v40, v29, v31, s9 bitop3:0x7e
  v_cmp_ne_u32 vcc, 0, v40
  s_cbranch_vccz L_qpx_11
  s_sleep 8
  buffer_load_dwordx4 v[28:31], v8, s[48:51], s65 offen sc1
  s_sub_u32 s11, s11, 1
  s_cbranch_scc0 L_qp_10
  s_branch L_hfail
L_qpx_11:
L_qp_12:
  s_waitcnt vmcnt(0)
  v_bitop3_b32 v40, v33, v35, s9 bitop3:0x7e
  v_cmp_ne_u32 vcc, 0, v40
  s_cbranch_vccz L_qpx_13
  s_sleep 8
  buffer_load_dwordx4 v[32:35], v8, s[48:51], s66 offen sc1
  s_sub_u32 s11, s11, 1
  s_cbranch_scc0 L_qp_12
  s_branch L_hfail
L_qpx_13:
L_qp_14:
  s_waitcnt vmcnt(0)
  v_bitop3_b32 v40, v37, v39, s9 bitop3:0x7e
  v_cmp_ne_u32 vcc, 0, v40
  s_cbranch_vccz L_qpx_15
  s_sleep 8
  buffer_load_dwordx4 v[36:39], v8, s[48:51], s67 offen sc1
  s_sub_u32 s11, s11, 1
  s_cbranch_scc0 L_qp_14
  s_branch L_hfail
L_qpx_15:
  v_add_f32 v24, v24, v28
  v_add_f32 v26, v26, v30
  v_add_f32 v32, v32, v36
  v_add_f32 v34, v34, v38
  v_add_f32 v24, v24, v32
  v_add_f32 v26, v26, v34
  v_cvt_pk_bf16_f32 v24, v24, v26
  v_lshlrev_b32 v8, 2, v1
  s_lshl_b32 s64, s8, 8
  v_add_u32 v8, s64, v8
  ds_write_b32 v8, v24 offset:256
  s_waitcnt lgkmcnt(0)
  s_setprio 0
  s_barrier
  s_cmp_lg_u32 s8, 1
  s_cbranch_scc1 L_sfinal_back
  s_mov_b32 s68, 1
  s_branch L_sfinal
L_sfinal_back:
  s_cmp_lg_u32 s8, 0
  s_cbranch_scc1 L_rwait
  v_mov_b32 v8, 0
L_lw_16:
  ds_read_b32 v9, v8 offset:160
  s_waitcnt lgkmcnt(0)
  v_readfirstlane_b32 s64, v9
  s_nop 0
  s_cmp_le_u32 s64, 3
  s_cbranch_scc1 L_lwx_17
  s_sleep 8
  s_sub_u32 s11, s11, 1
  s_cbranch_scc0 L_lw_16
  s_branch L_hfail
L_lwx_17:
  s_mov_b32 s52, s36
  s_mov_b32 s53, s37
  s_mov_b32 s54, 256
  s_mov_b32 s55, 0x20000
  v_mov_b32 v10, 1
  s_mov_b64 exec, 1
  buffer_atomic_add v10, off, s[52:55], 0 sc0 sc1
  s_waitcnt vmcnt(0)
  s_mov_b64 exec, -1
  v_readfirstlane_b32 s12, v10
L_rpost0:
  s_nop 0
  s_add_u32 s12, s12, 1
  v_mov_b32 v8, 0
  v_mov_b32 v9, s12
  ds_write_b32 v8, v9 offset:144
  s_branch L_rgot
L_rwait:
  v_mov_b32 v8, 0
L_lw_18:
  ds_read_b32 v9, v8 offset:144
  s_waitcnt lgkmcnt(0)
  v_readfirstlane_b32 s12, v9
  s_nop 0
  s_cmp_lg_u32 s12, 0
  s_cbranch_scc1 L_lwx_19
  s_sleep 8
  s_sub_u32 s11, s11, 1
  s_cbranch_scc0 L_lw_18
  s_branch L_hfail
L_lwx_19:
L_rgot:
  s_sub_u32 s12, s12, 1
  s_cmp_ge_u32 s12, 98
  s_cbranch_scc1 L_rord
  s_sub_u32 s12, 97, s12
L_rord:
  s_cmp_ge_u32 s12, 98
  s_cbranch_scc1 L_hdone
  v_and_b32 v4, 15, v1
  v_lshrrev_b32 v5, 4, v1
  v_lshrrev_b32 v6, 2, v4
  v_lshl_add_u32 v6, v5, 3, v6
  v_and_b32 v7, 3, v4
  v_lshlrev_b32 v7, 3, v7
  v_and_b32 v8, 1, v1
  v_mul_u32_u24 v8, 1056, v8
  v_lshl_add_u32 v3, v5, 4, v8
  s_cmp_lt_u32 s12, 14
  s_cbranch_scc0 L_notc
  s_mov_b32 s52, s32
  s_mov_b32 s53, s33
  s_mov_b32 s54, 1605632
  s_mov_b32 s55, 0x20000
  s_mov_b32 s60, s34
  s_mov_b32 s61, s35
  s_mov_b32 s62, 1792
  s_mov_b32 s63, 0x20000
  s_mul_i32 s65, s8, 28672
  s_add_u32 s65, s65, 20480
  v_lshl_add_u32 v2, v6, 6, v7
  v_add_u32 v2, s65, v2
  v_and_b32 v5, 31, v1
  v_lshrrev_b32 v6, 5, v1
  s_lshl_b32 s64, s12, 5
  v_add_u32 v7, s64, v5
  v_mul_u32_u24 v14, 448, v6
  v_add_lshl_u32 v14, v14, v7, 1
  buffer_load_ushort v16, v14, s[56:59], 0 offen
  v_lshlrev_b32 v7, 3, v7
  v_lshl_add_u32 v7, v6, 2, v7
  s_waitcnt vmcnt(0)
  v_lshlrev_b32 v16, 16, v16
  v_lshlrev_b32 v10, 4, v1
  v_lshlrev_b32 v11, 4, v5
  s_mul_i32 s13, s8, 3584
  s_add_u32 s13, s13, 139264
  s_mov_b32 s64, 0
  s_add_u32 s13, s13, s64
  s_mul_i32 s14, s8, 2112
  v_lshlrev_b32 v12, 2, v1
  v_add_u32 v12, s14, v12
  v_lshlrev_b32 v13, 2, v5
  v_add_u32 v13, s14, v13
  v_add_u32 v3, s14, v3
  s_lshl_b32 s64, s8, 8
  v_lshlrev_b32 v18, 3, v1
  v_add_u32 v18, s64, v18
  v_lshlrev_b32 v19, 3, v5
  v_lshl_add_u32 v19, v6, 2, v19
  v_mov_b32 v17, 0
  s_mov_b32 s64, 0x05040100
  s_mov_b32 s65, 0x07060302
  s_mov_b32 s68, 1
  s_branch L_c_go
L_c_poll:
  s_mov_b32 s68, 0
  v_mov_b32 v8, 0
L_lw_20:
  ds_read_b32 v9, v8 offset:132
  s_waitcnt lgkmcnt(0)
  v_readfirstlane_b32 s64, v9
  s_nop 0
  s_cmp_ge_u32 s64, 5
  s_cbranch_scc1 L_lwx_21
  s_sleep 2
  s_sub_u32 s11, s11, 1
  s_cbranch_scc0 L_lw_20
  s_branch L_hfail
L_lwx_21:
  s_waitcnt vmcnt(0)
  s_mul_i32 s64, s8, 401408
  s_lshl_b32 s65, s12, 6
  s_add_u32 s64, s64, s65
  s_mul_i32 s65, s8, 28672
  s_add_u32 s65, s65, 20480
  v_lshrrev_b32 v20, 2, v1
  v_mul_u32_u24 v20, 896, v20
  v_and_b32 v21, 3, v1
  v_lshl_add_u32 v20, v21, 4, v20
  s_mov_b32 s66, 28
L_dma_22:
  s_mov_b32 m0, s65
  s_add_u32 s65, s65, 1024
  buffer_load_dwordx4 v20, s[52:55], s64 offen nt lds
  s_add_u32 s64, s64, 14336
  s_waitcnt vmcnt(7)
  s_sub_u32 s66, s66, 1
  s_cmp_lg_u32 s66, 0
  s_cbranch_scc1 L_dma_22
  s_waitcnt vmcnt(0)
  ds_read_b64_tr_b16 v[64:65], v2 offset:0
  ds_read_b64_tr_b16 v[66:67], v2 offset:256
  ds_read_b64_tr_b16 v[68:69], v2 offset:2048
  ds_read_b64_tr_b16 v[70:71], v2 offset:2304
  ds_read_b64_tr_b16 v[72:73], v2 offset:4096
  ds_read_b64_tr_b16 v[74:75], v2 offset:4352
  ds_read_b64_tr_b16 v[76:77], v2 offset:6144
  ds_read_b64_tr_b16 v[78:79], v2 offset:6400
  s_waitcnt lgkmcnt(0)
  ds_read_b64_tr_b16 v[80:81], v2 offset:8192
  ds_read_b64_tr_b16 v[82:83], v2 offset:8448
  ds_read_b64_tr_b16 v[84:85], v2 offset:10240
  ds_read_b64_tr_b16 v[86:87], v2 offset:10496
  ds_read_b64_tr_b16 v[88:89], v2 offset:12288
  ds_read_b64_tr_b16 v[90:91], v2 offset:12544
  ds_read_b64_tr_b16 v[92:93], v2 offset:14336
  ds_read_b64_tr_b16 v[94:95], v2 offset:14592
  s_waitcnt lgkmcnt(0)
  ds_read_b64_tr_b16 v[96:97], v2 offset:16384
  ds_read_b64_tr_b16 v[98:99], v2 offset:16640
  ds_read_b64_tr_b16 v[100:101], v2 offset:18432
  ds_read_b64_tr_b16 v[102:103], v2 offset:18688
  ds_read_b64_tr_b16 v[104:105], v2 offset:20480
  ds_read_b64_tr_b16 v[106:107], v2 offset:20736
  ds_read_b64_tr_b16 v[108:109], v2 offset:22528
  ds_read_b64_tr_b16 v[110:111], v2 offset:22784
  s_waitcnt lgkmcnt(0)
  ds_read_b64_tr_b16 v[112:113], v2 offset:24576
  ds_read_b64_tr_b16 v[114:115], v2 offset:24832
  ds_read_b64_tr_b16 v[116:117], v2 offset:26624
  ds_read_b64_tr_b16 v[118:119], v2 offset:26880
  s_waitcnt lgkmcnt(0)
  ds_read_b64_tr_b16 v[120:121], v2 offset:32
  ds_read_b64_tr_b16 v[122:123], v2 offset:288
  ds_read_b64_tr_b16 v[124:125], v2 offset:2080
  ds_read_b64_tr_b16 v[126:127], v2 offset:2336
  ds_read_b64_tr_b16 v[128:129], v2 offset:4128
  ds_read_b64_tr_b16 v[130:131], v2 offset:4384
  ds_read_b64_tr_b16 v[132:133], v2 offset:6176
  ds_read_b64_tr_b16 v[134:135], v2 offset:6432
  s_waitcnt lgkmcnt(0)
  ds_read_b64_tr_b16 v[136:137], v2 offset:8224
  ds_read_b64_tr_b16 v[138:139], v2 offset:8480
  ds_read_b64_tr_b16 v[140:141], v2 offset:10272
  ds_read_b64_tr_b16 v[142:143], v2 offset:10528
  ds_read_b64_tr_b16 v[144:145], v2 offset:12320
  ds_read_b64_tr_b16 v[146:147], v2 offset:12576
  ds_read_b64_tr_b16 v[148:149], v2 offset:14368
  ds_read_b64_tr_b16 v[150:151], v2 offset:14624
  s_waitcnt lgkmcnt(0)
  ds_read_b64_tr_b16 v[152:153], v2 offset:16416
  ds_read_b64_tr_b16 v[154:155], v2 offset:16672
  ds_read_b64_tr_b16 v[156:157], v2 offset:18464
  ds_read_b64_tr_b16 v[158:159], v2 offset:18720
  ds_read_b64_tr_b16 v[160:161], v2 offset:20512
  ds_read_b64_tr_b16 v[162:163], v2 offset:20768
  ds_read_b64_tr_b16 v[164:165], v2 offset:22560
  ds_read_b64_tr_b16 v[166:167], v2 offset:22816
  s_waitcnt lgkmcnt(0)
  ds_read_b64_tr_b16 v[168:169], v2 offset:24608
  ds_read_b64_tr_b16 v[170:171], v2 offset:24864
  ds_read_b64_tr_b16 v[172:173], v2 offset:26656
  ds_read_b64_tr_b16 v[174:175], v2 offset:26912
  s_waitcnt lgkmcnt(0)
  s_cmp_lg_u32 s8, 0
  s_cbranch_scc1 L_gateo_25
  v_lshlrev_b32 v8, 5, v1
  s_mov_b32 s64, 73728
L_gate_23:
  buffer_load_dwordx4 v[40:43], v8, s[48:51], s64 offen sc1
  buffer_load_dwordx4 v[44:47], v8, s[48:51], s64 offen offset:16 sc1
  s_waitcnt vmcnt(0)
  v_xor_b32 v41, s9, v41
  v_xor_b32 v43, s9, v43
  v_xor_b32 v45, s9, v45
  v_xor_b32 v47, s9, v47
  v_or3_b32 v41, v41, v43, v45
  v_or_b32 v41, v41, v47
  v_cmp_ne_u32 vcc, 0, v41
  s_nop 0
  s_bcnt1_i32_b64 s65, vcc
  s_cmp_le_u32 s65, 32
  s_cbranch_scc1 L_gatex_24
  s_mov_b64 exec, vcc
  s_sleep 4
  s_sub_u32 s11, s11, 1
  s_cbranch_scc0 L_gate_23
  s_branch L_hfail
L_gatex_24:
  s_mov_b64 exec, -1
  v_mov_b32 v8, 0
  v_mov_b32 v9, 1
  ds_write_b32 v8, v9 offset:148
  s_branch L_gatee_26
L_gateo_25:
  v_mov_b32 v8, 0
L_lw_27:
  ds_read_b32 v9, v8 offset:148
  s_waitcnt lgkmcnt(0)
  v_readfirstlane_b32 s64, v9
  s_nop 0
  s_cmp_eq_u32 s64, 1
  s_cbranch_scc1 L_lwx_28
  s_sleep 2
  s_sub_u32 s11, s11, 1
  s_cbranch_scc0 L_lw_27
  s_branch L_hfail
L_lwx_28:
L_gatee_26:
  s_cmp_lg_u32 s8, 0
  s_cbranch_scc1 L_cnres_29
  s_mov_b32 s47, 0
  s_add_u32 s40, s47, 81920
  s_add_u32 s41, s47, 85504
  s_add_u32 s42, s47, 89088
  s_add_u32 s43, s47, 92672
  s_add_u32 s44, s47, 96256
  s_add_u32 s45, s47, 99840
  s_add_u32 s46, s47, 103424
  s_add_u32 s47, s47, 107008
L_sa_30:
  buffer_load_dword v176, v7, s[48:51], s40 offen sc1
  buffer_load_dword v177, v7, s[48:51], s41 offen sc1
  buffer_load_dword v178, v7, s[48:51], s42 offen sc1
  buffer_load_dword v179, v7, s[48:51], s43 offen sc1
  buffer_load_dword v180, v7, s[48:51], s44 offen sc1
  buffer_load_dword v181, v7, s[48:51], s45 offen sc1
  buffer_load_dword v182, v7, s[48:51], s46 offen sc1
  buffer_load_dword v183, v7, s[48:51], s47 offen sc1
  s_sub_u32 s11, s11, 1
  s_cbranch_scc1 L_hfail
  s_waitcnt vmcnt(0)
  v_bitop3_b32 v24, v176, v177, s96 bitop3:0x7e
  v_bitop3_b32 v25, v178, v179, s96 bitop3:0x7e
  v_bitop3_b32 v26, v180, v181, s96 bitop3:0x7e
  v_bitop3_b32 v27, v182, v183, s96 bitop3:0x7e
  v_or3_b32 v24, v24, v25, v26
  v_or_b32 v24, v24, v27
  v_and_b32 v24, 0x3f, v24
  v_cmp_ne_u32 vcc, 0, v24
  s_cbranch_vccnz L_sa_30
  v_add_f32 v17, v176, v177
  v_add_f32 v17, v17, v178
  v_add_f32 v17, v17, v179
  v_add_f32 v17, v17, v180
  v_add_f32 v17, v17, v181
  v_add_f32 v17, v17, v182
  v_add_f32 v17, v17, v183
  v_cvt_pk_bf16_f32 v17, v17, v17
  v_lshlrev_b32 v17, 16, v17
  v_add_f32 v17, v17, v16
  v_cvt_pk_bf16_f32 v17, v17, v17
  v_lshlrev_b32 v17, 16, v17
L_cnres_29:
  s_mov_b32 s64, 0x05040100
  s_mov_b32 s65, 0x07060302
  buffer_load_dwordx4 v[24:27], v10, s[48:51], s13 offen offset:0 sc1
  buffer_load_dwordx4 v[28:31], v10, s[48:51], s13 offen offset:1024 sc1
  buffer_load_dwordx4 v[32:35], v10, s[48:51], s13 offen offset:2048 sc1
  buffer_load_dwordx4 v[36:39], v11, s[48:51], s13 offen offset:3072 sc1
L_sp_32:
  s_waitcnt vmcnt(0)
  v_bitop3_b32 v248, v25, v27, s9 bitop3:0x7e
  v_bitop3_b32 v249, v29, v31, s9 bitop3:0x7e
  v_bitop3_b32 v250, v33, v35, s9 bitop3:0x7e
  v_bitop3_b32 v251, v37, v39, s9 bitop3:0x7e
  v_or3_b32 v248, v248, v249, v250
  v_or_b32 v248, v248, v251
  v_cmp_ne_u32 vcc, 0, v248
  s_cbranch_vccz L_spg_34
  buffer_load_dwordx4 v[24:27], v10, s[48:51], s13 offen offset:0 sc1
  buffer_load_dwordx4 v[28:31], v10, s[48:51], s13 offen offset:1024 sc1
  buffer_load_dwordx4 v[32:35], v10, s[48:51], s13 offen offset:2048 sc1
  buffer_load_dwordx4 v[36:39], v11, s[48:51], s13 offen offset:3072 sc1
  s_sub_u32 s11, s11, 1
  s_cbranch_scc0 L_sp_32
  s_branch L_hfail
L_spg_34:
L_c_go:
  v_perm_b32 v25, v26, v24, s64
  v_perm_b32 v27, v26, v24, s65
  ds_write_b32 v12, v25 offset:2048
  ds_write_b32 v12, v27 offset:3104
  v_perm_b32 v29, v30, v28, s64
  v_perm_b32 v31, v30, v28, s65
  ds_write_b32 v12, v29 offset:2304
  ds_write_b32 v12, v31 offset:3360
  v_perm_b32 v33, v34, v32, s64
  v_perm_b32 v35, v34, v32, s65
  ds_write_b32 v12, v33 offset:2560
  ds_write_b32 v12, v35 offset:3616
  v_perm_b32 v37, v38, v36, s64
  v_perm_b32 v39, v38, v36, s65
  ds_write_b32 v13, v37 offset:2816
  ds_write_b32 v13, v39 offset:3872
L_spj_33:
  ds_read_b128 v[176:179], v3 offset:2048
  ds_read_b128 v[180:183], v3 offset:2112
  ds_read_b128 v[184:187], v3 offset:2176
  ds_read_b128 v[188:191], v3 offset:2240
  ds_read_b128 v[192:195], v3 offset:2304
  ds_read_b128 v[196:199], v3 offset:2368
  ds_read_b128 v[200:203], v3 offset:2432
  s_waitcnt lgkmcnt(6)
  v_mfma_f32_16x16x32_bf16 v[40:43], v[176:179], v[64:67], 0
  v_mfma_f32_16x16x32_bf16 v[44:47], v[176:179], v[120:123], 0
  ds_read_b128 v[204:207], v3 offset:2496
  s_waitcnt lgkmcnt(6)
  v_mfma_f32_16x16x32_bf16 v[40:43], v[180:183], v[68:71], v[40:43]
  v_mfma_f32_16x16x32_bf16 v[44:47], v[180:183], v[124:127], v[44:47]
  ds_read_b128 v[208:211], v3 offset:2560
  s_waitcnt lgkmcnt(6)
  v_mfma_f32_16x16x32_bf16 v[40:43], v[184:187], v[72:75], v[40:43]
  v_mfma_f32_16x16x32_bf16 v[44:47], v[184:187], v[128:131], v[44:47]
  ds_read_b128 v[212:215], v3 offset:2624
  s_waitcnt lgkmcnt(6)
  v_mfma_f32_16x16x32_bf16 v[40:43], v[188:191], v[76:79], v[40:43]
  v_mfma_f32_16x16x32_bf16 v[44:47], v[188:191], v[132:135], v[44:47]
  ds_read_b128 v[216:219], v3 offset:2688
  s_waitcnt lgkmcnt(6)
  v_mfma_f32_16x16x32_bf16 v[40:43], v[192:195], v[80:83], v[40:43]
  v_mfma_f32_16x16x32_bf16 v[44:47], v[192:195], v[136:139], v[44:47]
  ds_read_b128 v[220:223], v3 offset:2752
  s_waitcnt lgkmcnt(6)
  v_mfma_f32_16x16x32_bf16 v[40:43], v[196:199], v[84:87], v[40:43]
  v_mfma_f32_16x16x32_bf16 v[44:47], v[196:199], v[140:143], v[44:47]
  ds_read_b128 v[224:227], v3 offset:2816
  s_waitcnt lgkmcnt(6)
  v_mfma_f32_16x16x32_bf16 v[40:43], v[200:203], v[88:91], v[40:43]
  v_mfma_f32_16x16x32_bf16 v[44:47], v[200:203], v[144:147], v[44:47]
  ds_read_b128 v[228:231], v3 offset:2880
  s_waitcnt lgkmcnt(6)
  v_mfma_f32_16x16x32_bf16 v[40:43], v[204:207], v[92:95], v[40:43]
  v_mfma_f32_16x16x32_bf16 v[44:47], v[204:207], v[148:151], v[44:47]
  s_waitcnt lgkmcnt(5)
  v_mfma_f32_16x16x32_bf16 v[40:43], v[208:211], v[96:99], v[40:43]
  v_mfma_f32_16x16x32_bf16 v[44:47], v[208:211], v[152:155], v[44:47]
  s_waitcnt lgkmcnt(4)
  v_mfma_f32_16x16x32_bf16 v[40:43], v[212:215], v[100:103], v[40:43]
  v_mfma_f32_16x16x32_bf16 v[44:47], v[212:215], v[156:159], v[44:47]
  s_waitcnt lgkmcnt(3)
  v_mfma_f32_16x16x32_bf16 v[40:43], v[216:219], v[104:107], v[40:43]
  v_mfma_f32_16x16x32_bf16 v[44:47], v[216:219], v[160:163], v[44:47]
  s_waitcnt lgkmcnt(2)
  v_mfma_f32_16x16x32_bf16 v[40:43], v[220:223], v[108:111], v[40:43]
  v_mfma_f32_16x16x32_bf16 v[44:47], v[220:223], v[164:167], v[44:47]
  s_waitcnt lgkmcnt(1)
  v_mfma_f32_16x16x32_bf16 v[40:43], v[224:227], v[112:115], v[40:43]
  v_mfma_f32_16x16x32_bf16 v[44:47], v[224:227], v[168:171], v[44:47]
  s_waitcnt lgkmcnt(0)
  v_mfma_f32_16x16x32_bf16 v[40:43], v[228:231], v[116:119], v[40:43]
  v_mfma_f32_16x16x32_bf16 v[44:47], v[228:231], v[172:175], v[44:47]
  s_mov_b64 exec, 0xffff
  s_nop 5
  ds_write_b64 v18, v[40:41] offset:10752
  ds_write_b64 v18, v[44:45] offset:10880
  s_mov_b64 exec, -1
  s_waitcnt lgkmcnt(0)
  s_cmp_eq_u32 s68, 1
  s_cbranch_scc1 L_nb_35
  s_barrier
L_nb_35:
  ds_read_b32 v20, v19 offset:10752
  ds_read_b32 v21, v19 offset:11008
  ds_read_b32 v22, v19 offset:11264
  ds_read_b32 v23, v19 offset:11520
  s_cmp_eq_u32 s68, 1
  s_cselect_b32 s64, 0, s8
  s_cmp_lg_u32 s64, 0
  s_cbranch_scc1 L_cend_36
  s_waitcnt lgkmcnt(0)
  v_add_f32 v20, v20, v21
  v_add_f32 v22, v22, v23
  v_add_f32 v20, v20, v22
  v_cvt_pk_bf16_f32 v20, v20, v20
  v_lshlrev_b32 v20, 16, v20
  v_add_f32 v20, v20, v17
  v_cvt_pk_bf16_f32 v20, v20, v20
  s_cmp_eq_u32 s68, 1
  s_cbranch_scc1 L_c_poll
  buffer_store_short v20, v14, s[60:63], 0 offen
  s_cmp_lg_u32 s12, 0
  s_cbranch_scc1 L_cend_36
  v_mov_b32 v21, s9
  s_mov_b64 exec, 1
  buffer_store_dword v21, off, s[48:51], 0 offset:0 sc1
L_cend_36:
  s_endpgm
L_notc:
  s_sub_u32 s12, s12, 14
  s_cmp_lt_u32 s12, 28
  s_cbranch_scc0 L_notb
  s_mov_b32 s52, s28
  s_mov_b32 s53, s29
  s_mov_b32 s54, 1605632
  s_mov_b32 s55, 0x20000
  s_mov_b32 s60, s30
  s_mov_b32 s61, s31
  s_mov_b32 s62, 1605632
  s_mov_b32 s63, 0x20000
  s_mul_i32 s64, s8, 56
  v_min_u32 v5, 55, v1
  v_add_u32 v5, s64, v5
  v_cmp_gt_u32 s[70:71], 56, v1
  v_lshlrev_b32 v14, 2, v5
  buffer_load_dword v16, v14, s[56:59], 0 offen
  buffer_load_dword v17, v14, s[56:59], 0 offen offset:896
  v_lshlrev_b32 v5, 4, v5
  s_waitcnt vmcnt(0)
  v_and_b32 v18, 0xffff0000, v16
  v_and_b32 v19, 0xffff0000, v17
  v_lshlrev_b32 v16, 16, v16
  v_lshlrev_b32 v17, 16, v17
  s_mov_b32 s47, 0
  s_add_u32 s40, s47, 81920
  s_add_u32 s41, s47, 85504
  s_add_u32 s42, s47, 89088
  s_add_u32 s43, s47, 92672
  s_add_u32 s44, s47, 96256
  s_add_u32 s45, s47, 99840
  s_add_u32 s46, s47, 103424
  s_add_u32 s47, s47, 107008
  s_lshl_b32 s64, s8, 4
  v_mov_b32 v10, s64
  v_and_b32 v11, 7, v1
  v_lshlrev_b32 v11, 4, v11
  v_lshlrev_b32 v12, 3, v1
  v_and_b32 v8, 16, v1
  v_cmp_ne_u32 s[56:57], 0, v8
  s_lshl_b32 s13, s12, 9
  s_lshl_b32 s64, s8, 7
  s_add_u32 s13, s13, s64
  s_add_u32 s13, s13, 139264
  s_add_u32 s58, s13, 65536
  s_mov_b32 s14, 0x3d372713
  s_mov_b32 s15, 0x42e00000
  v_mov_b32 v35, s9
  s_mov_b32 s68, 1
  s_branch L_b_go
L_b_poll:
  s_mov_b32 s68, 0
  s_mov_b32 s52, s28
  s_mov_b32 s53, s29
  s_mov_b32 s54, 1605632
  s_mov_b32 s55, 0x20000
  v_mov_b32 v8, 0
L_lw_37:
  ds_read_b32 v9, v8 offset:132
  s_waitcnt lgkmcnt(0)
  v_readfirstlane_b32 s64, v9
  s_nop 0
  s_cmp_ge_u32 s64, 5
  s_cbranch_scc1 L_lwx_38
  s_sleep 2
  s_sub_u32 s11, s11, 1
  s_cbranch_scc0 L_lw_37
  s_branch L_hfail
L_lwx_38:
  s_waitcnt vmcnt(0)
  v_lshrrev_b32 v20, 3, v1
  v_mul_u32_u24 v20, 3584, v20
  v_and_b32 v21, 7, v1
  v_lshl_add_u32 v20, v21, 4, v20
  s_lshl_b32 s64, s12, 7
  s_mul_i32 s65, s8, 401408
  s_add_u32 s64, s64, s65
  s_mul_i32 s65, s8, 14336
  s_add_u32 s65, s65, 20480
  s_mov_b32 s66, 14
L_dma_39:
  s_mov_b32 m0, s65
  s_add_u32 s65, s65, 1024
  buffer_load_dwordx4 v20, s[52:55], s64 offen nt lds
  s_add_u32 s64, s64, 28672
  s_waitcnt vmcnt(7)
  s_sub_u32 s66, s66, 1
  s_cmp_lg_u32 s66, 0
  s_cbranch_scc1 L_dma_39
  s_lshl_b32 s64, s12, 7
  s_mul_i32 s65, s8, 401408
  s_add_u32 s64, s64, s65
  s_mul_i32 s65, s8, 14336
  s_add_u32 s65, s65, 77824
  s_mov_b32 s66, 14
L_dma_40:
  s_mov_b32 m0, s65
  s_add_u32 s65, s65, 1024
  buffer_load_dwordx4 v20, s[60:63], s64 offen nt lds
  s_add_u32 s64, s64, 28672
  s_waitcnt vmcnt(7)
  s_sub_u32 s66, s66, 1
  s_cmp_lg_u32 s66, 0
  s_cbranch_scc1 L_dma_40
  s_waitcnt vmcnt(0)
  v_mov_b32 v8, 0
  v_mov_b32 v9, 1
  s_mov_b64 exec, 1
  ds_add_u32 v8, v9 offset:136
  s_mov_b64 exec, -1
L_hs_41:
  ds_read_b32 v9, v8 offset:136
  s_waitcnt lgkmcnt(0)
  v_readfirstlane_b32 s64, v9
  s_nop 0
  s_cmp_ge_u32 s64, 4
  s_cbranch_scc1 L_hsx_42
  s_sleep 2
  s_sub_u32 s11, s11, 1
  s_cbranch_scc0 L_hs_41
  s_branch L_hfail
L_hsx_42:
  s_lshl_b32 s64, s8, 5
  s_add_u32 s64, s64, 20480
  v_lshl_add_u32 v2, v6, 7, v7
  v_add_u32 v2, s64, v2
  ds_read_b64_tr_b16 v[64:65], v2 offset:0
  ds_read_b64_tr_b16 v[66:67], v2 offset:512
  ds_read_b64_tr_b16 v[68:69], v2 offset:4096
  ds_read_b64_tr_b16 v[70:71], v2 offset:4608
  ds_read_b64_tr_b16 v[72:73], v2 offset:8192
  ds_read_b64_tr_b16 v[74:75], v2 offset:8704
  ds_read_b64_tr_b16 v[76:77], v2 offset:12288
  ds_read_b64_tr_b16 v[78:79], v2 offset:12800
  s_waitcnt lgkmcnt(0)
  ds_read_b64_tr_b16 v[80:81], v2 offset:16384
  ds_read_b64_tr_b16 v[82:83], v2 offset:16896
  ds_read_b64_tr_b16 v[84:85], v2 offset:20480
  ds_read_b64_tr_b16 v[86:87], v2 offset:20992
  ds_read_b64_tr_b16 v[88:89], v2 offset:24576
  ds_read_b64_tr_b16 v[90:91], v2 offset:25088
  ds_read_b64_tr_b16 v[92:93], v2 offset:28672
  ds_read_b64_tr_b16 v[94:95], v2 offset:29184
  s_waitcnt lgkmcnt(0)
  ds_read_b64_tr_b16 v[96:97], v2 offset:32768
  ds_read_b64_tr_b16 v[98:99], v2 offset:33280
  ds_read_b64_tr_b16 v[100:101], v2 offset:36864
  ds_read_b64_tr_b16 v[102:103], v2 offset:37376
  ds_read_b64_tr_b16 v[104:105], v2 offset:40960
  ds_read_b64_tr_b16 v[106:107], v2 offset:41472
  ds_read_b64_tr_b16 v[108:109], v2 offset:45056
  ds_read_b64_tr_b16 v[110:111], v2 offset:45568
  s_waitcnt lgkmcnt(0)
  ds_read_b64_tr_b16 v[112:113], v2 offset:49152
  ds_read_b64_tr_b16 v[114:115], v2 offset:49664
  ds_read_b64_tr_b16 v[116:117], v2 offset:53248
  ds_read_b64_tr_b16 v[118:119], v2 offset:53760
  s_waitcnt lgkmcnt(0)
  v_add_u32 v2, 57344, v2
  ds_read_b64_tr_b16 v[120:121], v2 offset:0
  ds_read_b64_tr_b16 v[122:123], v2 offset:512
  ds_read_b64_tr_b16 v[124:125], v2 offset:4096
  ds_read_b64_tr_b16 v[126:127], v2 offset:4608
  ds_read_b64_tr_b16 v[128:129], v2 offset:8192
  ds_read_b64_tr_b16 v[130:131], v2 offset:8704
  ds_read_b64_tr_b16 v[132:133], v2 offset:12288
  ds_read_b64_tr_b16 v[134:135], v2 offset:12800
  s_waitcnt lgkmcnt(0)
  ds_read_b64_tr_b16 v[136:137], v2 offset:16384
  ds_read_b64_tr_b16 v[138:139], v2 offset:16896
  ds_read_b64_tr_b16 v[140:141], v2 offset:20480
  ds_read_b64_tr_b16 v[142:143], v2 offset:20992
  ds_read_b64_tr_b16 v[144:145], v2 offset:24576
  ds_read_b64_tr_b16 v[146:147], v2 offset:25088
  ds_read_b64_tr_b16 v[148:149], v2 offset:28672
  ds_read_b64_tr_b16 v[150:151], v2 offset:29184
  s_waitcnt lgkmcnt(0)
  ds_read_b64_tr_b16 v[152:153], v2 offset:32768
  ds_read_b64_tr_b16 v[154:155], v2 offset:33280
  ds_read_b64_tr_b16 v[156:157], v2 offset:36864
  ds_read_b64_tr_b16 v[158:159], v2 offset:37376
  ds_read_b64_tr_b16 v[160:161], v2 offset:40960
  ds_read_b64_tr_b16 v[162:163], v2 offset:41472
  ds_read_b64_tr_b16 v[164:165], v2 offset:45056
  ds_read_b64_tr_b16 v[166:167], v2 offset:45568
  s_waitcnt lgkmcnt(0)
  ds_read_b64_tr_b16 v[168:169], v2 offset:49152
  ds_read_b64_tr_b16 v[170:171], v2 offset:49664
  ds_read_b64_tr_b16 v[172:173], v2 offset:53248
  ds_read_b64_tr_b16 v[174:175], v2 offset:53760
  s_waitcnt lgkmcnt(0)
  s_cmp_lg_u32 s8, 0
  s_cbranch_scc1 L_gateo_45
  v_lshlrev_b32 v8, 5, v1
  s_mov_b32 s64, 73728
L_gate_43:
  buffer_load_dwordx4 v[40:43], v8, s[48:51], s64 offen sc1
  buffer_load_dwordx4 v[44:47], v8, s[48:51], s64 offen offset:16 sc1
  s_waitcnt vmcnt(0)
  v_xor_b32 v41, s9, v41
  v_xor_b32 v43, s9, v43
  v_xor_b32 v45, s9, v45
  v_xor_b32 v47, s9, v47
  v_or3_b32 v41, v41, v43, v45
  v_or_b32 v41, v41, v47
  v_cmp_ne_u32 vcc, 0, v41
  s_nop 0
  s_bcnt1_i32_b64 s65, vcc
  s_cmp_le_u32 s65, 32
  s_cbranch_scc1 L_gatex_44
  s_mov_b64 exec, vcc
  s_sleep 4
  s_sub_u32 s11, s11, 1
  s_cbranch_scc0 L_gate_43
  s_branch L_hfail
L_gatex_44:
  s_mov_b64 exec, -1
  v_mov_b32 v8, 0
  v_mov_b32 v9, 1
  ds_write_b32 v8, v9 offset:148
  s_branch L_gatee_46
L_gateo_45:
  v_mov_b32 v8, 0
L_lw_47:
  ds_read_b32 v9, v8 offset:148
  s_waitcnt lgkmcnt(0)
  v_readfirstlane_b32 s64, v9
  s_nop 0
  s_cmp_eq_u32 s64, 1
  s_cbranch_scc1 L_lwx_48
  s_sleep 2
  s_sub_u32 s11, s11, 1
  s_cbranch_scc0 L_lw_47
  s_branch L_hfail
L_lwx_48:
L_gatee_46:
L_sa_49:
  buffer_load_dwordx4 v[176:179], v5, s[48:51], s40 offen sc1
  buffer_load_dwordx4 v[180:183], v5, s[48:51], s41 offen sc1
  buffer_load_dwordx4 v[184:187], v5, s[48:51], s42 offen sc1
  buffer_load_dwordx4 v[188:191], v5, s[48:51], s43 offen sc1
  buffer_load_dwordx4 v[192:195], v5, s[48:51], s44 offen sc1
  buffer_load_dwordx4 v[196:199], v5, s[48:51], s45 offen sc1
  buffer_load_dwordx4 v[200:203], v5, s[48:51], s46 offen sc1
  buffer_load_dwordx4 v[204:207], v5, s[48:51], s47 offen sc1
  s_sub_u32 s11, s11, 1
  s_cbranch_scc1 L_hfail
  s_waitcnt vmcnt(0)
  v_bitop3_b32 v240, v176, v178, s96 bitop3:0x7e
  v_bitop3_b32 v241, v180, v182, s96 bitop3:0x7e
  v_bitop3_b32 v242, v184, v186, s96 bitop3:0x7e
  v_bitop3_b32 v243, v188, v190, s96 bitop3:0x7e
  v_bitop3_b32 v244, v192, v194, s96 bitop3:0x7e
  v_bitop3_b32 v245, v196, v198, s96 bitop3:0x7e
  v_bitop3_b32 v246, v200, v202, s96 bitop3:0x7e
  v_bitop3_b32 v247, v204, v206, s96 bitop3:0x7e
  v_or3_b32 v240, v240, v241, v242
  v_or3_b32 v243, v243, v244, v245
  v_or3_b32 v240, v240, v243, v246
  v_or_b32 v240, v240, v247
  v_and_b32 v240, 0x3f, v240
  v_cmp_ne_u32 vcc, 0, v240
  s_cbranch_vccnz L_sa_49
L_b_go:
  v_pk_add_f32 v[20:21], v[176:177], v[180:181]
  v_pk_add_f32 v[22:23], v[178:179], v[182:183]
  v_pk_add_f32 v[20:21], v[20:21], v[184:185]
  v_pk_add_f32 v[22:23], v[22:23], v[186:187]
  v_pk_add_f32 v[20:21], v[20:21], v[188:189]
  v_pk_add_f32 v[22:23], v[22:23], v[190:191]
  v_pk_add_f32 v[20:21], v[20:21], v[192:193]
  v_pk_add_f32 v[22:23], v[22:23], v[194:195]
  v_pk_add_f32 v[20:21], v[20:21], v[196:197]
  v_pk_add_f32 v[22:23], v[22:23], v[198:199]
  v_pk_add_f32 v[20:21], v[20:21], v[200:201]
  v_pk_add_f32 v[22:23], v[22:23], v[202:203]
  v_pk_add_f32 v[20:21], v[20:21], v[204:205]
  v_pk_add_f32 v[22:23], v[22:23], v[206:207]
  v_cvt_pk_bf16_f32 v24, v20, v21
  v_cvt_pk_bf16_f32 v25, v22, v23
  v_lshlrev_b32 v20, 16, v24
  v_and_b32 v21, 0xffff0000, v24
  v_lshlrev_b32 v22, 16, v25
  v_and_b32 v23, 0xffff0000, v25
  v_pk_add_f32 v[20:21], v[20:21], v[16:17]
  v_pk_add_f32 v[22:23], v[22:23], v[18:19]
  v_cvt_pk_bf16_f32 v24, v20, v21
  v_cvt_pk_bf16_f32 v25, v22, v23
  v_lshlrev_b32 v20, 16, v24
  v_and_b32 v21, 0xffff0000, v24
  v_lshlrev_b32 v22, 16, v25
  v_and_b32 v23, 0xffff0000, v25
  v_readfirstlane_b32 s66, v20
  v_readfirstlane_b32 s67, v21
  s_nop 1
  v_pk_add_f32 v[36:37], v[20:21], s[66:67] neg_lo:[0,1] neg_hi:[0,1]
  v_pk_add_f32 v[38:39], v[22:23], s[66:67] neg_lo:[0,1] neg_hi:[0,1]
  v_mov_b32 v24, s66
  v_mov_b32 v28, s67
  v_add_f32 v25, v36, v38
  v_add_f32 v29, v37, v39
  v_mul_f32 v26, v36, v36
  v_mul_f32 v30, v37, v37
  v_fmac_f32 v26, v38, v38
  v_fmac_f32 v30, v39, v39
  v_cndmask_b32 v25, 0, v25, s[70:71]
  v_cndmask_b32 v29, 0, v29, s[70:71]
  v_cndmask_b32 v26, 0, v26, s[70:71]
  v_cndmask_b32 v30, 0, v30, s[70:71]
  v_add_f32_dpp v25, v25, v25 quad_perm:[1,0,3,2] row_mask:0xf bank_mask:0xf
  v_add_f32_dpp v29, v29, v29 quad_perm:[1,0,3,2] row_mask:0xf bank_mask:0xf
  v_add_f32_dpp v26, v26, v26 quad_perm:[1,0,3,2] row_mask:0xf bank_mask:0xf
  v_add_f32_dpp v30, v30, v30 quad_perm:[1,0,3,2] row_mask:0xf bank_mask:0xf
  v_add_f32_dpp v25, v25, v25 quad_perm:[2,3,0,1] row_mask:0xf bank_mask:0xf
  v_add_f32_dpp v29, v29, v29 quad_perm:[2,3,0,1] row_mask:0xf bank_mask:0xf
  v_add_f32_dpp v26, v26, v26 quad_perm:[2,3,0,1] row_mask:0xf bank_mask:0xf
  v_add_f32_dpp v30, v30, v30 quad_perm:[2,3,0,1] row_mask:0xf bank_mask:0xf
  v_add_f32_dpp v25, v25, v25 row_half_mirror row_mask:0xf bank_mask:0xf
  v_add_f32_dpp v29, v29, v29 row_half_mirror row_mask:0xf bank_mask:0xf
  v_add_f32_dpp v26, v26, v26 row_half_mirror row_mask:0xf bank_mask:0xf
  v_add_f32_dpp v30, v30, v30 row_half_mirror row_mask:0xf bank_mask:0xf
  v_add_f32_dpp v25, v25, v25 row_mirror row_mask:0xf bank_mask:0xf
  v_add_f32_dpp v29, v29, v29 row_mirror row_mask:0xf bank_mask:0xf
  v_add_f32_dpp v26, v26, v26 row_mirror row_mask:0xf bank_mask:0xf
  v_add_f32_dpp v30, v30, v30 row_mirror row_mask:0xf bank_mask:0xf
  v_add_f32_dpp v25, v25, v25 row_bcast:15 row_mask:0xa bank_mask:0xf
  v_add_f32_dpp v29, v29, v29 row_bcast:15 row_mask:0xa bank_mask:0xf
  v_add_f32_dpp v26, v26, v26 row_bcast:15 row_mask:0xa bank_mask:0xf
  v_add_f32_dpp v30, v30, v30 row_bcast:15 row_mask:0xa bank_mask:0xf
  v_add_f32_dpp v25, v25, v25 row_bcast:31 row_mask:0xc bank_mask:0xf
  v_add_f32_dpp v29, v29, v29 row_bcast:31 row_mask:0xc bank_mask:0xf
  v_add_f32_dpp v26, v26, v26 row_bcast:31 row_mask:0xc bank_mask:0xf
  v_add_f32_dpp v30, v30, v30 row_bcast:31 row_mask:0xc bank_mask:0xf
  s_mov_b32 exec_lo, 0
  s_mov_b32 exec_hi, 0x80000000
  ds_write_b96 v10, v[24:26] offset:1536
  ds_write_b96 v10, v[28:30] offset:1600
  s_mov_b64 exec, -1
  s_waitcnt lgkmcnt(0)
  s_cmp_eq_u32 s68, 1
  s_cbranch_scc1 L_nb_51
  s_barrier
L_nb_51:
  ds_read_b96 v[24:26], v11 offset:1536
  s_waitcnt lgkmcnt(0)
  v_mul_f32 v27, 0x3c124925, v25
  v_add_f32 v24, v24, v27
  v_fma_f32 v26, -v27, v25, v26
  s_nop 0
  v_add_f32_dpp v28, v24, v24 quad_perm:[1,0,3,2] row_mask:0xf bank_mask:0xf
  s_nop 1
  v_add_f32_dpp v28, v28, v28 quad_perm:[2,3,0,1] row_mask:0xf bank_mask:0xf
  v_mul_f32 v28, 0x3e800000, v28
  v_sub_f32 v24, v24, v28
  v_mul_f32 v24, v24, v24
  v_fmac_f32 v26, s15, v24
  s_nop 1
  v_add_f32_dpp v26, v26, v26 quad_perm:[1,0,3,2] row_mask:0xf bank_mask:0xf
  s_nop 1
  v_add_f32_dpp v26, v26, v26 quad_perm:[2,3,0,1] row_mask:0xf bank_mask:0xf
  v_mul_f32 v26, 0x3b124925, v26
  v_cvt_pk_bf16_f32 v27, v28, v26
  v_and_b32 v26, 0xffff0000, v27
  v_lshlrev_b32 v28, 16, v27
  v_add_f32 v26, 0x3727c5ac, v26
  v_readlane_b32 s52, v28, 0
  v_readlane_b32 s53, v28, 4
  v_cvt_pk_bf16_f32 v26, v26, v26
  v_lshlrev_b32 v26, 16, v26
  v_pk_add_f32 v[20:21], v[20:21], s[52:53] neg_lo:[0,1] neg_hi:[0,1]
  v_sqrt_f32 v26, v26
  v_pk_add_f32 v[22:23], v[22:23], s[52:53] neg_lo:[0,1] neg_hi:[0,1]
  v_cvt_pk_bf16_f32 v26, v26, v26
  v_lshlrev_b32 v26, 16, v26
  v_cvt_pk_bf16_f32 v24, v20, v21
  v_rcp_f32 v26, v26
  v_cvt_pk_bf16_f32 v25, v22, v23
  v_lshlrev_b32 v20, 16, v24
  v_readlane_b32 s54, v26, 0
  v_readlane_b32 s55, v26, 4
  v_and_b32 v21, 0xffff0000, v24
  v_lshlrev_b32 v22, 16, v25
  v_and_b32 v23, 0xffff0000, v25
  v_pk_mul_f32 v[20:21], v[20:21], s[54:55]
  v_pk_mul_f32 v[22:23], v[22:23], s[54:55]
  v_cvt_pk_bf16_f32 v20, v20, v22
  v_cvt_pk_bf16_f32 v21, v21, v23
  ds_write_b32 v14, v20 offset:2048
  ds_write_b32 v14, v21 offset:3104
  s_waitcnt lgkmcnt(0)
  s_cmp_eq_u32 s68, 1
  s_cbranch_scc1 L_nb_52
  s_barrier
L_nb_52:
  ds_read_b128 v[176:179], v3 offset:2048
  ds_read_b128 v[180:183], v3 offset:2112
  ds_read_b128 v[184:187], v3 offset:2176
  ds_read_b128 v[188:191], v3 offset:2240
  ds_read_b128 v[192:195], v3 offset:2304
  ds_read_b128 v[196:199], v3 offset:2368
  ds_read_b128 v[200:203], v3 offset:2432
  ds_read_b128 v[204:207], v3 offset:2496
  ds_read_b128 v[208:211], v3 offset:2560
  ds_read_b128 v[212:215], v3 offset:2624
  ds_read_b128 v[216:219], v3 offset:2688
  ds_read_b128 v[220:223], v3 offset:2752
  s_waitcnt lgkmcnt(11)
  v_mfma_f32_16x16x32_bf16 v[24:27], v[176:179], v[64:67], 0
  v_mfma_f32_16x16x32_bf16 v[28:31], v[176:179], v[120:123], 0
  ds_read_b128 v[224:227], v3 offset:2816
  s_waitcnt lgkmcnt(11)
  v_mfma_f32_16x16x32_bf16 v[24:27], v[180:183], v[68:71], v[24:27]
  v_mfma_f32_16x16x32_bf16 v[28:31], v[180:183], v[124:127], v[28:31]
  ds_read_b128 v[228:231], v3 offset:2880
  s_waitcnt lgkmcnt(11)
  v_mfma_f32_16x16x32_bf16 v[24:27], v[184:187], v[72:75], v[24:27]
  v_mfma_f32_16x16x32_bf16 v[28:31], v[184:187], v[128:131], v[28:31]
  s_waitcnt lgkmcnt(10)
  v_mfma_f32_16x16x32_bf16 v[24:27], v[188:191], v[76:79], v[24:27]
  v_mfma_f32_16x16x32_bf16 v[28:31], v[188:191], v[132:135], v[28:31]
  s_waitcnt lgkmcnt(9)
  v_mfma_f32_16x16x32_bf16 v[24:27], v[192:195], v[80:83], v[24:27]
  v_mfma_f32_16x16x32_bf16 v[28:31], v[192:195], v[136:139], v[28:31]
  s_waitcnt lgkmcnt(8)
  v_mfma_f32_16x16x32_bf16 v[24:27], v[196:199], v[84:87], v[24:27]
  v_mfma_f32_16x16x32_bf16 v[28:31], v[196:199], v[140:143], v[28:31]
  s_waitcnt lgkmcnt(7)
  v_mfma_f32_16x16x32_bf16 v[24:27], v[200:203], v[88:91], v[24:27]
  v_mfma_f32_16x16x32_bf16 v[28:31], v[200:203], v[144:147], v[28:31]
  s_waitcnt lgkmcnt(6)
  v_mfma_f32_16x16x32_bf16 v[24:27], v[204:207], v[92:95], v[24:27]
  v_mfma_f32_16x16x32_bf16 v[28:31], v[204:207], v[148:151], v[28:31]
  s_waitcnt lgkmcnt(5)
  v_mfma_f32_16x16x32_bf16 v[24:27], v[208:211], v[96:99], v[24:27]
  v_mfma_f32_16x16x32_bf16 v[28:31], v[208:211], v[152:155], v[28:31]
  s_waitcnt lgkmcnt(4)
  v_mfma_f32_16x16x32_bf16 v[24:27], v[212:215], v[100:103], v[24:27]
  v_mfma_f32_16x16x32_bf16 v[28:31], v[212:215], v[156:159], v[28:31]
  s_waitcnt lgkmcnt(3)
  v_mfma_f32_16x16x32_bf16 v[24:27], v[216:219], v[104:107], v[24:27]
  v_mfma_f32_16x16x32_bf16 v[28:31], v[216:219], v[160:163], v[28:31]
  s_waitcnt lgkmcnt(2)
  v_mfma_f32_16x16x32_bf16 v[24:27], v[220:223], v[108:111], v[24:27]
  v_mfma_f32_16x16x32_bf16 v[28:31], v[220:223], v[164:167], v[28:31]
  s_waitcnt lgkmcnt(1)
  v_mfma_f32_16x16x32_bf16 v[24:27], v[224:227], v[112:115], v[24:27]
  v_mfma_f32_16x16x32_bf16 v[28:31], v[224:227], v[168:171], v[28:31]
  s_waitcnt lgkmcnt(0)
  v_mfma_f32_16x16x32_bf16 v[24:27], v[228:231], v[116:119], v[24:27]
  v_mfma_f32_16x16x32_bf16 v[28:31], v[228:231], v[172:175], v[28:31]
  s_nop 6
  v_cndmask_b32 v24, v24, v25, s[56:57]
  v_cndmask_b32 v29, v28, v29, s[56:57]
  v_cvt_pk_bf16_f32 v29, v24, v29
  v_lshlrev_b32 v28, 16, v29
  v_and_b32 v29, 0xffff0000, v29
  v_mul_f32 v32, v28, v28
  v_mul_f32 v32, v32, v28
  v_fma_f32 v32, v32, s14, v28
  v_mul_f32 v32, 0xc0135761, v32
  v_exp_f32 v32, v32
  s_nop 0
  v_add_f32 v32, 1.0, v32
  v_rcp_f32 v32, v32
  s_nop 0
  v_mul_f32 v32, v32, v28
  v_cvt_pk_bf16_f32 v32, v32, v32
  v_lshlrev_b32 v32, 16, v32
  v_mul_f32 v32, v32, v29
  v_mov_b32 v33, v32
  s_nop 1
  v_permlane16_swap_b32 v32, v33
  v_cvt_pk_bf16_f32 v34, v32, v33
  s_cmp_eq_u32 s68, 1
  s_cbranch_scc1 L_b_poll
  s_mov_b64 exec, 0xffff
  buffer_store_dwordx2 v[34:35], v12, s[48:51], s13 offen sc1
  s_endpgm
L_notb:
  s_sub_u32 s12, s12, 28
  s_mul_i32 s7, s12, 37
  s_lshr_b32 s7, s7, 8
  s_mul_i32 s64, s7, 7
  s_sub_u32 s5, s12, s64
  s_mov_b32 s52, s24
  s_mov_b32 s53, s25
  s_mov_b32 s54, 3670016
  s_mov_b32 s55, 0x20000
  s_mul_i32 s64, s7, 458752
  s_lshl_b32 s65, s5, 7
  s_add_u32 s64, s64, s65
  s_mul_i32 s65, s8, 114688
  s_add_u32 s64, s64, s65
  s_lshl_b32 s65, s8, 14
  s_add_u32 s65, s65, 20480
  v_lshrrev_b32 v20, 3, v1
  v_mul_u32_u24 v20, 896, v20
  v_and_b32 v21, 7, v1
  v_lshl_add_u32 v20, v21, 4, v20
  s_mov_b32 s66, 16
L_dma_53:
  s_mov_b32 m0, s65
  s_add_u32 s65, s65, 1024
  buffer_load_dwordx4 v20, s[52:55], s64 offen nt lds
  s_add_u32 s64, s64, 7168
  s_waitcnt vmcnt(5)
  s_sub_u32 s66, s66, 1
  s_cmp_lg_u32 s66, 0
  s_cbranch_scc1 L_dma_53
  s_waitcnt vmcnt(0)
  v_mov_b32 v8, 0
  v_mov_b32 v9, 1
  s_mov_b64 exec, 1
  ds_add_u32 v8, v9 offset:136
  s_mov_b64 exec, -1
L_hs_54:
  ds_read_b32 v9, v8 offset:136
  s_waitcnt lgkmcnt(0)
  v_readfirstlane_b32 s64, v9
  s_nop 0
  s_cmp_ge_u32 s64, 4
  s_cbranch_scc1 L_hsx_55
  s_sleep 2
  s_sub_u32 s11, s11, 1
  s_cbranch_scc0 L_hs_54
  s_branch L_hfail
L_hsx_55:
  s_lshl_b32 s64, s8, 5
  s_add_u32 s64, s64, 20480
  v_lshl_add_u32 v2, v6, 7, v7
  v_add_u32 v2, s64, v2
  ds_read_b64_tr_b16 v[64:65], v2 offset:0
  ds_read_b64_tr_b16 v[66:67], v2 offset:512
  ds_read_b64_tr_b16 v[68:69], v2 offset:4096
  ds_read_b64_tr_b16 v[70:71], v2 offset:4608
  ds_read_b64_tr_b16 v[72:73], v2 offset:8192
  ds_read_b64_tr_b16 v[74:75], v2 offset:8704
  ds_read_b64_tr_b16 v[76:77], v2 offset:12288
  ds_read_b64_tr_b16 v[78:79], v2 offset:12800
  s_waitcnt lgkmcnt(0)
  ds_read_b64_tr_b16 v[80:81], v2 offset:16384
  ds_read_b64_tr_b16 v[82:83], v2 offset:16896
  ds_read_b64_tr_b16 v[84:85], v2 offset:20480
  ds_read_b64_tr_b16 v[86:87], v2 offset:20992
  ds_read_b64_tr_b16 v[88:89], v2 offset:24576
  ds_read_b64_tr_b16 v[90:91], v2 offset:25088
  ds_read_b64_tr_b16 v[92:93], v2 offset:28672
  ds_read_b64_tr_b16 v[94:95], v2 offset:29184
  s_waitcnt lgkmcnt(0)
  ds_read_b64_tr_b16 v[96:97], v2 offset:32768
  ds_read_b64_tr_b16 v[98:99], v2 offset:33280
  ds_read_b64_tr_b16 v[100:101], v2 offset:36864
  ds_read_b64_tr_b16 v[102:103], v2 offset:37376
  ds_read_b64_tr_b16 v[104:105], v2 offset:40960
  ds_read_b64_tr_b16 v[106:107], v2 offset:41472
  ds_read_b64_tr_b16 v[108:109], v2 offset:45056
  ds_read_b64_tr_b16 v[110:111], v2 offset:45568
  s_waitcnt lgkmcnt(0)
  ds_read_b64_tr_b16 v[112:113], v2 offset:49152
  ds_read_b64_tr_b16 v[114:115], v2 offset:49664
  ds_read_b64_tr_b16 v[116:117], v2 offset:53248
  ds_read_b64_tr_b16 v[118:119], v2 offset:53760
  ds_read_b64_tr_b16 v[120:121], v2 offset:57344
  ds_read_b64_tr_b16 v[122:123], v2 offset:57856
  ds_read_b64_tr_b16 v[124:125], v2 offset:61440
  ds_read_b64_tr_b16 v[126:127], v2 offset:61952
  s_waitcnt lgkmcnt(0)
  s_waitcnt lgkmcnt(0)
  s_lshr_b32 s12, s8, 1
  s_and_b32 s13, s8, 1
  s_lshl_b32 s14, s12, 3
  s_add_u32 s14, s14, s7
  s_lshl_b32 s15, s14, 15
  s_lshl_b32 s64, s13, 10
  s_add_u32 s15, s15, s64
  s_add_u32 s15, s15, 262144
  s_lshl_b32 s64, s13, 11
  s_lshl_b32 s14, s14, 7
  s_add_u32 s14, s14, s64
  s_add_u32 s14, s14, 73728
  v_lshlrev_b32 v5, 4, v1
  v_lshlrev_b32 v6, 3, v4
  s_mul_i32 s64, s12, 1056
  s_lshl_b32 s65, s13, 9
  s_add_u32 s64, s64, s65
  v_lshlrev_b32 v7, 3, v1
  v_add_u32 v7, s64, v7
  v_lshlrev_b32 v18, 3, v1
  v_mov_b32 v19, 0xffffffc0
  s_mul_i32 s52, s7, 3584
  s_lshl_b32 s65, s5, 9
  s_add_u32 s52, s52, s65
  s_lshl_b32 s65, s8, 7
  s_add_u32 s52, s52, s65
  s_add_u32 s52, s52, 81920
  s_add_u32 s53, s52, 131072
  s_mov_b32 s68, 1
  s_branch L_a_go
L_a_poll:
  s_mov_b32 s68, 0
  s_mov_b32 s69, 0xffff
  s_mov_b32 s70, 0
  v_mov_b32 v12, 0xff800000
  v_mov_b32 v13, 0
  v_mov_b32 v14, 0
  v_mov_b32 v15, 0
  v_mov_b32 v16, 0
  v_mov_b32 v17, 0
L_asw_56:
  buffer_load_dwordx2 v[10:11], v6, s[48:51], s14 offen sc1
  s_ff1_i32_b32 s40, s70
  s_cmp_lt_i32 s40, 0
  s_cbranch_scc1 L_ais_58
  s_lshl_b32 s64, s40, 11
  s_bitset0_b32 s70, s40
  s_add_u32 s64, s64, s15
  buffer_load_dwordx4 v[128:131], v5, s[48:51], s64 offen sc1
  s_ff1_i32_b32 s41, s70
  s_cmp_lt_i32 s41, 0
  s_cbranch_scc1 L_ais_58
  s_lshl_b32 s64, s41, 11
  s_bitset0_b32 s70, s41
  s_add_u32 s64, s64, s15
  buffer_load_dwordx4 v[132:135], v5, s[48:51], s64 offen sc1
  s_ff1_i32_b32 s42, s70
  s_cmp_lt_i32 s42, 0
  s_cbranch_scc1 L_ais_58
  s_lshl_b32 s64, s42, 11
  s_bitset0_b32 s70, s42
  s_add_u32 s64, s64, s15
  buffer_load_dwordx4 v[136:139], v5, s[48:51], s64 offen sc1
  s_ff1_i32_b32 s43, s70
  s_cmp_lt_i32 s43, 0
  s_cbranch_scc1 L_ais_58
  s_lshl_b32 s64, s43, 11
  s_bitset0_b32 s70, s43
  s_add_u32 s64, s64, s15
  buffer_load_dwordx4 v[140:143], v5, s[48:51], s64 offen sc1
  s_ff1_i32_b32 s44, s70
  s_cmp_lt_i32 s44, 0
  s_cbranch_scc1 L_ais_58
  s_lshl_b32 s64, s44, 11
  s_bitset0_b32 s70, s44
  s_add_u32 s64, s64, s15
  buffer_load_dwordx4 v[144:147], v5, s[48:51], s64 offen sc1
  s_ff1_i32_b32 s45, s70
  s_cmp_lt_i32 s45, 0
  s_cbranch_scc1 L_ais_58
  s_lshl_b32 s64, s45, 11
  s_bitset0_b32 s70, s45
  s_add_u32 s64, s64, s15
  buffer_load_dwordx4 v[148:151], v5, s[48:51], s64 offen sc1
L_ais_58:
  s_waitcnt vmcnt(0)
  v_cmp_eq_u32 s[66:67], s9, v11
  s_cmp_lt_i32 s40, 0
  s_cbranch_scc1 L_ack_59
  v_readlane_b32 s64, v10, s40
  v_bitop3_b32 v28, v128, v130, s96 bitop3:0x7e
  v_and_b32 v28, 0x3f, v28
  v_cmp_ne_u32 vcc, 0, v28
  s_cbranch_vccnz L_anx_60
  s_bitcmp1_b32 s66, s40
  s_cbranch_scc0 L_anx_60
  v_max_f32 v28, s64, v12
  v_sub_f32 v24, v12, v28
  v_sub_f32 v26, s64, v28
  v_exp_f32 v24, v24
  v_exp_f32 v26, v26
  v_mov_b32 v12, v28
  s_bitset0_b32 s69, s40
  v_pk_mul_f32 v[14:15], v[14:15], v[24:25] op_sel_hi:[1,0]
  v_pk_mul_f32 v[16:17], v[16:17], v[24:25] op_sel_hi:[1,0]
  v_fma_f32 v13, v13, v24, v26
  v_pk_fma_f32 v[14:15], v[128:129], v[26:27], v[14:15] op_sel_hi:[1,0,1]
  v_pk_fma_f32 v[16:17], v[130:131], v[26:27], v[16:17] op_sel_hi:[1,0,1]
L_anx_60:
  s_cmp_lt_i32 s41, 0
  s_cbranch_scc1 L_ack_59
  v_readlane_b32 s64, v10, s41
  v_bitop3_b32 v28, v132, v134, s96 bitop3:0x7e
  v_and_b32 v28, 0x3f, v28
  v_cmp_ne_u32 vcc, 0, v28
  s_cbranch_vccnz L_anx_61
  s_bitcmp1_b32 s66, s41
  s_cbranch_scc0 L_anx_61
  v_max_f32 v28, s64, v12
  v_sub_f32 v24, v12, v28
  v_sub_f32 v26, s64, v28
  v_exp_f32 v24, v24
  v_exp_f32 v26, v26
  v_mov_b32 v12, v28
  s_bitset0_b32 s69, s41
  v_pk_mul_f32 v[14:15], v[14:15], v[24:25] op_sel_hi:[1,0]
  v_pk_mul_f32 v[16:17], v[16:17], v[24:25] op_sel_hi:[1,0]
  v_fma_f32 v13, v13, v24, v26
  v_pk_fma_f32 v[14:15], v[132:133], v[26:27], v[14:15] op_sel_hi:[1,0,1]
  v_pk_fma_f32 v[16:17], v[134:135], v[26:27], v[16:17] op_sel_hi:[1,0,1]
L_anx_61:
  s_cmp_lt_i32 s42, 0
  s_cbranch_scc1 L_ack_59
  v_readlane_b32 s64, v10, s42
  v_bitop3_b32 v28, v136, v138, s96 bitop3:0x7e
  v_and_b32 v28, 0x3f, v28
  v_cmp_ne_u32 vcc, 0, v28
  s_cbranch_vccnz L_anx_62
  s_bitcmp1_b32 s66, s42
  s_cbranch_scc0 L_anx_62
  v_max_f32 v28, s64, v12
  v_sub_f32 v24, v12, v28
  v_sub_f32 v26, s64, v28
  v_exp_f32 v24, v24
  v_exp_f32 v26, v26
  v_mov_b32 v12, v28
  s_bitset0_b32 s69, s42
  v_pk_mul_f32 v[14:15], v[14:15], v[24:25] op_sel_hi:[1,0]
  v_pk_mul_f32 v[16:17], v[16:17], v[24:25] op_sel_hi:[1,0]
  v_fma_f32 v13, v13, v24, v26
  v_pk_fma_f32 v[14:15], v[136:137], v[26:27], v[14:15] op_sel_hi:[1,0,1]
  v_pk_fma_f32 v[16:17], v[138:139], v[26:27], v[16:17] op_sel_hi:[1,0,1]
L_anx_62:
  s_cmp_lt_i32 s43, 0
  s_cbranch_scc1 L_ack_59
  v_readlane_b32 s64, v10, s43
  v_bitop3_b32 v28, v140, v142, s96 bitop3:0x7e
  v_and_b32 v28, 0x3f, v28
  v_cmp_ne_u32 vcc, 0, v28
  s_cbranch_vccnz L_anx_63
  s_bitcmp1_b32 s66, s43
  s_cbranch_scc0 L_anx_63
  v_max_f32 v28, s64, v12
  v_sub_f32 v24, v12, v28
  v_sub_f32 v26, s64, v28
  v_exp_f32 v24, v24
  v_exp_f32 v26, v26
  v_mov_b32 v12, v28
  s_bitset0_b32 s69, s43
  v_pk_mul_f32 v[14:15], v[14:15], v[24:25] op_sel_hi:[1,0]
  v_pk_mul_f32 v[16:17], v[16:17], v[24:25] op_sel_hi:[1,0]
  v_fma_f32 v13, v13, v24, v26
  v_pk_fma_f32 v[14:15], v[140:141], v[26:27], v[14:15] op_sel_hi:[1,0,1]
  v_pk_fma_f32 v[16:17], v[142:143], v[26:27], v[16:17] op_sel_hi:[1,0,1]
L_anx_63:
  s_cmp_lt_i32 s44, 0
  s_cbranch_scc1 L_ack_59
  v_readlane_b32 s64, v10, s44
  v_bitop3_b32 v28, v144, v146, s96 bitop3:0x7e
  v_and_b32 v28, 0x3f, v28
  v_cmp_ne_u32 vcc, 0, v28
  s_cbranch_vccnz L_anx_64
  s_bitcmp1_b32 s66, s44
  s_cbranch_scc0 L_anx_64
  v_max_f32 v28, s64, v12
  v_sub_f32 v24, v12, v28
  v_sub_f32 v26, s64, v28
  v_exp_f32 v24, v24
  v_exp_f32 v26, v26
  v_mov_b32 v12, v28
  s_bitset0_b32 s69, s44
  v_pk_mul_f32 v[14:15], v[14:15], v[24:25] op_sel_hi:[1,0]
  v_pk_mul_f32 v[16:17], v[16:17], v[24:25] op_sel_hi:[1,0]
  v_fma_f32 v13, v13, v24, v26
  v_pk_fma_f32 v[14:15], v[144:145], v[26:27], v[14:15] op_sel_hi:[1,0,1]
  v_pk_fma_f32 v[16:17], v[146:147], v[26:27], v[16:17] op_sel_hi:[1,0,1]
L_anx_64:
  s_cmp_lt_i32 s45, 0
  s_cbranch_scc1 L_ack_59
  v_readlane_b32 s64, v10, s45
  v_bitop3_b32 v28, v148, v150, s96 bitop3:0x7e
  v_and_b32 v28, 0x3f, v28
  v_cmp_ne_u32 vcc, 0, v28
  s_cbranch_vccnz L_anx_65
  s_bitcmp1_b32 s66, s45
  s_cbranch_scc0 L_anx_65
  v_max_f32 v28, s64, v12
  v_sub_f32 v24, v12, v28
  v_sub_f32 v26, s64, v28
  v_exp_f32 v24, v24
  v_exp_f32 v26, v26
  v_mov_b32 v12, v28
  s_bitset0_b32 s69, s45
  v_pk_mul_f32 v[14:15], v[14:15], v[24:25] op_sel_hi:[1,0]
  v_pk_mul_f32 v[16:17], v[16:17], v[24:25] op_sel_hi:[1,0]
  v_fma_f32 v13, v13, v24, v26
  v_pk_fma_f32 v[14:15], v[148:149], v[26:27], v[14:15] op_sel_hi:[1,0,1]
  v_pk_fma_f32 v[16:17], v[150:151], v[26:27], v[16:17] op_sel_hi:[1,0,1]
L_anx_65:
L_ack_59:
  s_cmp_eq_u32 s69, 0
  s_cbranch_scc1 L_a_got
  s_and_b32 s70, s69, s66
  s_bcnt1_i32_b32 s64, s69
  s_cmp_le_u32 s64, 6
  s_cselect_b32 s70, s69, s70
  s_cmp_lg_u32 s70, 0
  s_cbranch_scc1 L_anl_57
  s_sleep 4
L_anl_57:
  s_sub_u32 s11, s11, 1
  s_cbranch_scc0 L_asw_56
  s_branch L_hfail
L_a_got:
L_a_go:
  v_rcp_f32 v24, v13
  s_nop 0
  v_pk_mul_f32 v[14:15], v[14:15], v[24:25] op_sel_hi:[1,0]
  v_pk_mul_f32 v[16:17], v[16:17], v[24:25] op_sel_hi:[1,0]
  v_cvt_pk_bf16_f32 v14, v14, v15
  v_cvt_pk_bf16_f32 v15, v16, v17
  ds_write_b64 v7, v[14:15] offset:2048
  s_waitcnt lgkmcnt(0)
  s_cmp_eq_u32 s68, 1
  s_cbranch_scc1 L_nb_66
  s_barrier
L_nb_66:
  ds_read_b128 v[192:195], v3 offset:2048
  ds_read_b128 v[196:199], v3 offset:2112
  ds_read_b128 v[200:203], v3 offset:2176
  ds_read_b128 v[204:207], v3 offset:2240
  ds_read_b128 v[208:211], v3 offset:2304
  ds_read_b128 v[212:215], v3 offset:2368
  ds_read_b128 v[216:219], v3 offset:2432
  ds_read_b128 v[220:223], v3 offset:2496
  ds_read_b128 v[224:227], v3 offset:2560
  ds_read_b128 v[228:231], v3 offset:2624
  ds_read_b128 v[232:235], v3 offset:2688
  ds_read_b128 v[236:239], v3 offset:2752
  s_waitcnt lgkmcnt(11)
  v_mfma_f32_16x16x32_bf16 v[20:23], v[192:195], v[64:67], 0
  ds_read_b128 v[240:243], v3 offset:2816
  s_waitcnt lgkmcnt(11)
  v_mfma_f32_16x16x32_bf16 v[20:23], v[196:199], v[68:71], v[20:23]
  ds_read_b128 v[244:247], v3 offset:2880
  s_waitcnt lgkmcnt(11)
  v_mfma_f32_16x16x32_bf16 v[20:23], v[200:203], v[72:75], v[20:23]
  ds_read_b128 v[248:251], v3 offset:2944
  s_waitcnt lgkmcnt(11)
  v_mfma_f32_16x16x32_bf16 v[20:23], v[204:207], v[76:79], v[20:23]
  ds_read_b128 v[252:255], v3 offset:3008
  s_waitcnt lgkmcnt(11)
  v_mfma_f32_16x16x32_bf16 v[20:23], v[208:211], v[80:83], v[20:23]
  s_waitcnt lgkmcnt(10)
  v_mfma_f32_16x16x32_bf16 v[20:23], v[212:215], v[84:87], v[20:23]
  s_waitcnt lgkmcnt(9)
  v_mfma_f32_16x16x32_bf16 v[20:23], v[216:219], v[88:91], v[20:23]
  s_waitcnt lgkmcnt(8)
  v_mfma_f32_16x16x32_bf16 v[20:23], v[220:223], v[92:95], v[20:23]
  s_waitcnt lgkmcnt(7)
  v_mfma_f32_16x16x32_bf16 v[20:23], v[224:227], v[96:99], v[20:23]
  s_waitcnt lgkmcnt(6)
  v_mfma_f32_16x16x32_bf16 v[20:23], v[228:231], v[100:103], v[20:23]
  s_waitcnt lgkmcnt(5)
  v_mfma_f32_16x16x32_bf16 v[20:23], v[232:235], v[104:107], v[20:23]
  s_waitcnt lgkmcnt(4)
  v_mfma_f32_16x16x32_bf16 v[20:23], v[236:239], v[108:111], v[20:23]
  s_waitcnt lgkmcnt(3)
  v_mfma_f32_16x16x32_bf16 v[20:23], v[240:243], v[112:115], v[20:23]
  s_waitcnt lgkmcnt(2)
  v_mfma_f32_16x16x32_bf16 v[20:23], v[244:247], v[116:119], v[20:23]
  s_waitcnt lgkmcnt(1)
  v_mfma_f32_16x16x32_bf16 v[20:23], v[248:251], v[120:123], v[20:23]
  s_waitcnt lgkmcnt(0)
  v_mfma_f32_16x16x32_bf16 v[20:23], v[252:255], v[124:127], v[20:23]
  s_nop 7
  v_and_or_b32 v24, v20, v19, s96
  v_and_or_b32 v25, v21, v19, s96
  s_cmp_eq_u32 s68, 1
  s_cbranch_scc1 L_a_poll
  s_mov_b64 exec, 0xffff
  buffer_store_dwordx2 v[24:25], v18, s[48:51], s52 offen sc1
  s_endpgm
L_hfail:
L_hdone:
  s_endpgm
L_exit:
  s_endpgm
.section .rodata,"a"
.p2align 6
.amdhsa_kernel sequential_preLN__gqa_block_cached__geglu_ffn__decode_kernel
  .amdhsa_next_free_vgpr 256
  .amdhsa_next_free_sgpr 102
  .amdhsa_accum_offset 256
  .amdhsa_group_segment_fixed_size 0
  .amdhsa_kernarg_size 96
  .amdhsa_user_sgpr_count 2
  .amdhsa_user_sgpr_kernarg_segment_ptr 1
  .amdhsa_system_sgpr_workgroup_id_x 1
.end_amdhsa_kernel
```
